```python
import torch

def _softmax(x, axis=-1):
    return torch.softmax(x, dim=axis)
def _gelu(x):
    return torch.nn.functional.gelu(x, approximate="tanh")
def _silu(x):
    return torch.nn.functional.silu(x)
def _sigmoid(x):
    return torch.sigmoid(x)
def _layernorm(x, axis=-1, eps=1e-5):
    m = x.mean(dim=axis, keepdim=True)
    v = x.var(dim=axis, keepdim=True, unbiased=False)
    return (x - m) / torch.sqrt(v + eps)
def _scatter_add(tgt, idx, src, axis=0):
    return tgt.clone().index_add_(axis, idx, src)
def _segment_sum(src, seg, n):
    out = torch.zeros((n,) + src.shape[1:], dtype=src.dtype)
    return out.index_add_(0, seg, src)
def _pad(x, pw):
    flat = tuple(v for pair in reversed(pw) for v in pair)
    return torch.nn.functional.pad(x, flat)

kernel_name = 'concat_heads__linear_attn_block__ssm_conv_h3__prompt'

def setup_inputs():

    _w = (lambda a: (lambda t: t.to(torch.bfloat16) if t.is_floating_point() else t)(torch.as_tensor(a)))
    def _A_setup():
        B, S, D = 1, 2048, 576
        return {
            "x": _w((lambda *s: torch.randn(*s, dtype=torch.bfloat16) * 0.05)(B, S, D)),
            "wqkv": _w((lambda *s: torch.randn(*s, dtype=torch.bfloat16) * 0.8)(D, 3 * D)),
            "wo": _w((lambda *s: torch.randn(*s, dtype=torch.bfloat16) * 0.05)(D, D)),
        }
    _A_in = _A_setup()

    def _B_setup():
        B, S, D = 1, 2048, 576
        ks = 4
        return {
            "q": _w((lambda *s: torch.randn(*s, dtype=torch.bfloat16) * 0.05)(B, S, D)),
            "k": _w((lambda *s: torch.randn(*s, dtype=torch.bfloat16) * 0.4)(B, S, D)),
            "v": _w((lambda *s: torch.randn(*s, dtype=torch.bfloat16) * 0.4)(B, S, D)),
            "shift_k": _w((lambda *s: torch.randn(*s, dtype=torch.bfloat16) * 0.4)(D, ks) * 0.5),
            "ssm_k": _w((lambda *s: torch.randn(*s, dtype=torch.bfloat16) * 1.6)(D, S) * (1.0 / S ** 0.5)),
            "ssm_D": _w((lambda *s: torch.randn(*s, dtype=torch.bfloat16) * 0.4)(D)),
        }
    _B_in = _B_setup()

    return {
        "A_x": _A_in["x"],
        "A_wqkv": _A_in["wqkv"],
        "A_wo": _A_in["wo"],
        "B_q": _B_in["q"],
        "B_k": _B_in["k"],
        "B_v": _B_in["v"],
        "B_shift_k": _B_in["shift_k"],
        "B_ssm_k": _B_in["ssm_k"],
        "B_ssm_D": _B_in["ssm_D"],
    }

def reference(A_x, A_wqkv, A_wo, B_q, B_k, B_v, B_shift_k, B_ssm_k, B_ssm_D):
    def _A_ref(x, wqkv, wo):
        B, S, D = x.shape
        H = 32; Dh = D // H
        qkv = (lambda x, *d: x.permute(*d))((x @ wqkv).reshape(B, S, 3, H, Dh), 2, 0, 3, 1, 4)
        q, k, v = qkv[0], qkv[1], qkv[2]
        phi = lambda t: torch.where(t > 0, t + 1, torch.exp(t)) + 1e-6
        pq, pk = phi(q), phi(k)
        kv = torch.einsum("bhsd,bhse->bhde", pk, v)
        z = torch.einsum("bhsd->bhd", pk)
        num = torch.einsum("bhqd,bhde->bhqe", pq, kv)
        den = torch.einsum("bhqd,bhd->bhq", pq, z)[..., None] + 1e-6
        o = num / den
        return (lambda x, *d: x.permute(*d))(o, 0, 2, 1, 3).reshape(B, S, D) @ wo

    def _B_ref(q, k, v, shift_k, ssm_k, ssm_D):
        B, S, D = q.shape
        ks = shift_k.shape[-1]
        k_pad = _pad(k, ((0, 0), (ks - 1, 0), (0, 0)))
        k_shift = torch.zeros_like(k)
        for t in range(ks):
            k_shift = k_shift + k_pad[:, t:t + S, :] * shift_k[:, ks - 1 - t][None, None, :]
        kv = k_shift * v
        L = 2 * S
        kv_pad = _pad(kv, ((0, 0), (0, S), (0, 0)))
        kf_pad = _pad(ssm_k, ((0, 0), (0, S)))
        kv_f = (lambda x, axes=(-2,-1): torch.fft.rfft2(x.float(), dim=axes))(kv_pad[:, None, :, :], axes=(1, 2))
        kf_f = (lambda x, axes=(-2,-1): torch.fft.rfft2(x.float(), dim=axes))(kf_pad[:, None, :], axes=(1, 2))
        kf_f = (lambda x, *d: x.permute(*d))(kf_f, 1, 2, 0)
        y_f = kv_f * kf_f[None, :, :, :]
        y = (lambda x, s, axes=(-2,-1): torch.fft.irfft2(x, s=s, dim=axes).to(torch.bfloat16))(y_f, (1, L), axes=(1, 2))[:, 0, :S, :]
        y = y + kv * ssm_D[None, None, :]
        return q * y

    a = _A_ref(A_x, A_wqkv, A_wo)
    b = _B_ref(B_q, B_k, B_v, B_shift_k, B_ssm_k, B_ssm_D)
    return torch.concatenate([a, b], axis=-1)
```

```asm
; @launch grid=(256,1,1) block=(512,1,1) lds=163840
.amdgcn_target "amdgcn-amd-amdhsa--gfx950"
.text
.globl concat_heads__linear_attn_block__ssm_conv_h3__prompt_kernel
.p2align 8
.type concat_heads__linear_attn_block__ssm_conv_h3__prompt_kernel,@function
concat_heads__linear_attn_block__ssm_conv_h3__prompt_kernel:
s_cmp_ge_u32 s2, 256
s_cbranch_scc1 concat_heads__linear_attn_block__ssm_conv_h3__prompt_kernel_end
s_load_dwordx16 s[4:19], s[0:1], 0
s_load_dwordx8 s[20:27], s[0:1], 64
v_lshrrev_b32 v1, 6, v0
v_and_b32 v0, 63, v0
s_and_b32 s71, s2, 7
s_lshr_b32 s72, s2, 3
v_readfirstlane_b32 s28, v1
s_mov_b32 s96, 0
s_and_b32 s56, s72, 7
s_cmp_eq_u32 s56, 0
s_cbranch_scc0 Lentrypf_1
s_getpc_b64 s[56:57]
Lpc_2:
s_lshl_b32 s59, s28, 13
v_lshlrev_b32 v2, 7, v0
v_add_u32 v2, s59, v2
v_min_u32 v2, Lcode_end - Lpc_2 - 4, v2
v_mov_b32 v5, s57
v_add_co_u32 v4, vcc, s56, v2
s_nop 1
v_addc_co_u32 v5, vcc, 0, v5, vcc
global_load_dword v238, v[4:5], off
Lentrypf_1:
s_cmp_ge_u32 s72, 24
s_cbranch_scc1 concat_heads__linear_attn_block__ssm_conv_h3__prompt_kernel_b
s_cmp_ge_u32 s72, 16
s_cbranch_scc1 concat_heads__linear_attn_block__ssm_conv_h3__prompt_kernel_q
s_and_b32 s41, s71, 3
s_lshl_b32 s41, s41, 2
s_and_b32 s29, s72, 3
s_add_u32 s29, s29, s41
s_lshr_b32 s41, s71, 2
s_lshl_b32 s41, s41, 2
s_lshr_b32 s30, s72, 2
s_add_u32 s30, s30, s41
s_and_b32 s41, s29, 3
s_lshl_b32 s41, s41, 1
s_and_b32 s42, s30, 3
s_mul_i32 s42, s42, 3
s_add_u32 s41, s41, s42
s_cmp_ge_u32 s41, 9
s_cselect_b32 s42, 9, 0
s_sub_u32 s41, s41, s42
s_lshl_b32 s46, s41, 7
s_mov_b32 s76, s46
s_add_u32 s46, s46, 128
s_cmp_eq_u32 s46, 1152
s_cselect_b32 s46, 0, s46
s_mov_b32 s77, s46
s_add_u32 s46, s46, 128
s_cmp_eq_u32 s46, 1152
s_cselect_b32 s46, 0, s46
s_mov_b32 s78, s46
s_add_u32 s46, s46, 128
s_cmp_eq_u32 s46, 1152
s_cselect_b32 s46, 0, s46
s_mov_b32 s79, s46
s_add_u32 s46, s46, 128
s_cmp_eq_u32 s46, 1152
s_cselect_b32 s46, 0, s46
s_mov_b32 s80, s46
s_add_u32 s46, s46, 128
s_cmp_eq_u32 s46, 1152
s_cselect_b32 s46, 0, s46
s_mov_b32 s81, s46
s_add_u32 s46, s46, 128
s_cmp_eq_u32 s46, 1152
s_cselect_b32 s46, 0, s46
s_mov_b32 s82, s46
s_add_u32 s46, s46, 128
s_cmp_eq_u32 s46, 1152
s_cselect_b32 s46, 0, s46
s_mov_b32 s83, s46
s_add_u32 s46, s46, 128
s_cmp_eq_u32 s46, 1152
s_cselect_b32 s46, 0, s46
s_mov_b32 s84, s46
v_lshrrev_b32 v2, 3, v0
v_and_b32 v3, 7, v0
v_xor_b32 v3, v3, v2
s_lshl_b32 s41, s29, 7
s_lshl_b32 s42, s28, 4
s_add_u32 s41, s41, s42
v_lshlrev_b32 v3, 4, v3
v_add_u32 v2, s41, v2
v_mul_u32_u24 v2, 1152, v2
v_add_u32 v16, v2, v3
s_mul_i32 s42, s30, 144
s_add_u32 s42, s42, 1152
s_lshl_b32 s41, s28, 6
s_lshl_b32 s43, s28, 7
v_add_u32 v2, s43, v0
v_mul_u32_u24 v3, 27595, v2
v_lshrrev_b32 v3, 22, v3
v_mul_u32_u24 v4, 152, v3
v_sub_u32 v4, v2, v4
v_min_u32 v4, 143, v4
v_mul_u32_u24 v5, 3641, v4
v_lshrrev_b32 v5, 16, v5
v_mul_u32_u24 v6, 18, v5
v_sub_u32 v6, v4, v6
v_lshl_add_u32 v5, v3, 3, v5
v_mul_u32_u24 v5, 3456, v5
v_cmp_le_u32 vcc, 9, v6
v_add_u32 v7, 63, v6
s_nop 0
v_cndmask_b32 v6, v6, v7, vcc
v_lshl_add_u32 v5, v6, 4, v5
v_add_u32 v17, s42, v5
v_add_u32 v2, s43, v0
v_add_u32 v2, 64, v2
v_mul_u32_u24 v3, 27595, v2
v_lshrrev_b32 v3, 22, v3
v_mul_u32_u24 v4, 152, v3
v_sub_u32 v4, v2, v4
v_min_u32 v4, 143, v4
v_mul_u32_u24 v5, 3641, v4
v_lshrrev_b32 v5, 16, v5
v_mul_u32_u24 v6, 18, v5
v_sub_u32 v6, v4, v6
v_lshl_add_u32 v5, v3, 3, v5
v_mul_u32_u24 v5, 3456, v5
v_cmp_le_u32 vcc, 9, v6
v_add_u32 v7, 63, v6
s_nop 0
v_cndmask_b32 v6, v6, v7, vcc
v_lshl_add_u32 v5, v6, 4, v5
v_add_u32 v18, s42, v5
v_add_u32 v2, s41, v0
v_add_u32 v2, 1024, v2
v_mul_u32_u24 v3, 27595, v2
v_lshrrev_b32 v3, 22, v3
v_mul_u32_u24 v4, 152, v3
v_sub_u32 v4, v2, v4
v_min_u32 v4, 143, v4
v_mul_u32_u24 v5, 3641, v4
v_lshrrev_b32 v5, 16, v5
v_mul_u32_u24 v6, 18, v5
v_sub_u32 v6, v4, v6
v_lshl_add_u32 v5, v3, 3, v5
v_mul_u32_u24 v5, 3456, v5
v_cmp_le_u32 vcc, 9, v6
v_add_u32 v7, 63, v6
s_nop 0
v_cndmask_b32 v6, v6, v7, vcc
v_lshl_add_u32 v5, v6, 4, v5
v_add_u32 v19, s42, v5
s_cmp_lt_u32 s28, 3
s_cselect_b32 s43, -1, 0
v_and_b32 v19, s43, v19
v_subrev_u32 v18, 1024, v18
v_add_u32 v22, 8192, v16
s_lshl_b32 s41, s28, 10
s_lshl_b32 s45, s28, 11
s_add_u32 s45, s45, 16384
s_add_u32 s41, s41, 32768
s_cmp_lt_u32 s28, 3
s_cselect_b32 s40, s41, 35840
s_lshl_b32 s44, s28, 11
s_and_b32 s41, s28, 3
s_lshl_b32 s41, s41, 12
v_and_b32 v2, 15, v0
v_lshrrev_b32 v3, 4, v0
v_and_b32 v4, 7, v2
v_xor_b32 v4, v4, v3
v_lshlrev_b32 v4, 4, v4
v_lshl_add_u32 v4, v2, 7, v4
v_add_u32 v10, s41, v4
v_xor_b32 v11, 64, v10
v_mul_u32_u24 v4, 2432, v3
v_bfe_u32 v5, v0, 2, 2
v_mul_u32_u24 v5, 288, v5
v_and_b32 v6, 3, v0
v_lshlrev_b32 v6, 3, v6
v_add3_u32 v4, v4, v5, v6
s_lshr_b32 s41, s28, 2
s_cmp_eq_u32 s41, 0
s_cselect_b32 s42, 0, 208
s_cselect_b32 s43, 48, 0
s_add_u32 s42, s42, 16384
s_add_u32 s43, s43, 16480
v_add_u32 v12, s42, v4
v_add_u32 v20, s43, v4
v_add_u32 v44, 0, v10
v_add_u32 v45, 0, v11
v_add_u32 v46, 0, v12
v_add_u32 v47, 0, v20
v_add_u32 v48, 36864, v10
v_add_u32 v49, 36864, v11
v_add_u32 v50, 36864, v12
v_add_u32 v51, 36864, v20
v_add_u32 v52, 73728, v10
v_add_u32 v53, 73728, v11
v_add_u32 v54, 73728, v12
v_add_u32 v55, 73728, v20
v_add_u32 v56, 110592, v10
v_add_u32 v57, 110592, v11
v_add_u32 v58, 110592, v12
v_add_u32 v59, 110592, v20
s_waitcnt lgkmcnt(0)
s_mov_b32 s64, s26
s_mov_b32 s65, s27
s_mov_b32 s66, 0x9d2000
s_mov_b32 s67, 0x20000
s_mov_b32 s32, s4
s_mov_b32 s33, s5
s_mov_b32 s34, 0x240000
s_mov_b32 s35, 0x20000
s_mov_b32 s36, s6
s_mov_b32 s37, s7
s_mov_b32 s38, 0x1e6000
s_mov_b32 s39, 0x20000
s_add_u32 m0, s44, 0
s_mul_i32 s47, s76, 1728
buffer_load_dwordx4 v16, s[32:35], s76 offen  lds
buffer_load_dwordx4 v22, s[32:35], s76 offen offset:1024  lds
s_add_u32 m0, s45, 0
s_nop 0
buffer_load_dwordx4 v17, s[36:39], s47 offen  lds
buffer_load_dwordx4 v18, s[36:39], s47 offen offset:1024  lds
s_add_u32 m0, s40, 0
s_nop 0
buffer_load_dwordx4 v19, s[36:39], s47 offen  lds
s_barrier
s_add_u32 m0, s44, 36864
s_mul_i32 s47, s77, 1728
buffer_load_dwordx4 v16, s[32:35], s77 offen  lds
buffer_load_dwordx4 v22, s[32:35], s77 offen offset:1024  lds
s_add_u32 m0, s45, 36864
s_nop 0
buffer_load_dwordx4 v17, s[36:39], s47 offen  lds
buffer_load_dwordx4 v18, s[36:39], s47 offen offset:1024  lds
s_add_u32 m0, s40, 36864
s_nop 0
buffer_load_dwordx4 v19, s[36:39], s47 offen  lds
s_or_b32 s68, s2, s28
s_cmp_eq_u32 s68, 0
s_cbranch_scc0 Lnpub_3
s_mov_b32 s60, s24
s_mov_b32 s61, s25
s_mov_b32 s62, 0x100
s_mov_b32 s63, 0x20000
s_memrealtime s[68:69]
v_mov_b32 v240, 0
s_waitcnt lgkmcnt(0)
s_or_b32 s68, s68, 1
v_mov_b32 v241, s68
s_mov_b64 s[68:69], exec
s_mov_b64 exec, 1
buffer_store_dword v241, v240, s[60:63], 0 offen sc1
s_mov_b64 exec, s[68:69]
Lnpub_3:
s_waitcnt vmcnt(5)
s_barrier
ds_read_b128 v[104:107], v44 offset:0
ds_read_b128 v[108:111], v44 offset:2048
ds_read_b64_tr_b16 v[120:121], v46 offset:0
ds_read_b64_tr_b16 v[122:123], v46 offset:1152
ds_read_b64_tr_b16 v[124:125], v46 offset:32
ds_read_b64_tr_b16 v[126:127], v46 offset:1184
ds_read_b64_tr_b16 v[128:129], v46 offset:64
ds_read_b64_tr_b16 v[130:131], v46 offset:1216
ds_read_b64_tr_b16 v[132:133], v47 offset:0
ds_read_b64_tr_b16 v[134:135], v47 offset:1152
ds_read_b64_tr_b16 v[136:137], v47 offset:32
ds_read_b64_tr_b16 v[138:139], v47 offset:1184
s_waitcnt lgkmcnt(6)
v_mfma_f32_16x16x32_bf16 v[64:67], v[104:107], v[120:123], 0
ds_read_b128 v[112:115], v45 offset:0
ds_read_b128 v[116:119], v45 offset:2048
v_mfma_f32_16x16x32_bf16 v[68:71], v[108:111], v[120:123], 0
ds_read_b64_tr_b16 v[140:141], v46 offset:9728
s_add_u32 m0, s44, 73728
s_mul_i32 s47, s78, 1728
buffer_load_dwordx4 v16, s[32:35], s78 offen  lds
buffer_load_dwordx4 v22, s[32:35], s78 offen offset:1024  lds
s_add_u32 m0, s45, 73728
s_nop 0
buffer_load_dwordx4 v17, s[36:39], s47 offen  lds
buffer_load_dwordx4 v18, s[36:39], s47 offen offset:1024  lds
s_add_u32 m0, s40, 73728
s_nop 0
buffer_load_dwordx4 v19, s[36:39], s47 offen  lds
v_mfma_f32_16x16x32_bf16 v[72:75], v[104:107], v[124:127], 0
ds_read_b64_tr_b16 v[142:143], v46 offset:10880
ds_read_b64_tr_b16 v[144:145], v46 offset:9760
v_mfma_f32_16x16x32_bf16 v[76:79], v[108:111], v[124:127], 0
ds_read_b64_tr_b16 v[146:147], v46 offset:10912
s_waitcnt lgkmcnt(8)
v_mfma_f32_16x16x32_bf16 v[80:83], v[104:107], v[128:131], 0
ds_read_b64_tr_b16 v[148:149], v46 offset:9792
ds_read_b64_tr_b16 v[150:151], v46 offset:10944
v_mfma_f32_16x16x32_bf16 v[84:87], v[108:111], v[128:131], 0
ds_read_b64_tr_b16 v[152:153], v47 offset:9728
v_mfma_f32_16x16x32_bf16 v[88:91], v[104:107], v[132:135], 0
ds_read_b64_tr_b16 v[154:155], v47 offset:10880
ds_read_b64_tr_b16 v[156:157], v47 offset:9760
v_mfma_f32_16x16x32_bf16 v[92:95], v[108:111], v[132:135], 0
ds_read_b64_tr_b16 v[158:159], v47 offset:10912
s_waitcnt lgkmcnt(12)
v_mfma_f32_16x16x32_bf16 v[96:99], v[104:107], v[136:139], 0
v_mfma_f32_16x16x32_bf16 v[100:103], v[108:111], v[136:139], 0
s_waitcnt vmcnt(5)
s_barrier
s_waitcnt lgkmcnt(6)
v_mfma_f32_16x16x32_bf16 v[64:67], v[112:115], v[140:143], v[64:67]
ds_read_b128 v[104:107], v48 offset:0
ds_read_b128 v[108:111], v48 offset:2048
v_mfma_f32_16x16x32_bf16 v[68:71], v[116:119], v[140:143], v[68:71]
ds_read_b64_tr_b16 v[120:121], v50 offset:0
s_add_u32 m0, s44, 110592
s_mul_i32 s47, s79, 1728
buffer_load_dwordx4 v16, s[32:35], s79 offen  lds
buffer_load_dwordx4 v22, s[32:35], s79 offen offset:1024  lds
s_add_u32 m0, s45, 110592
s_nop 0
buffer_load_dwordx4 v17, s[36:39], s47 offen  lds
buffer_load_dwordx4 v18, s[36:39], s47 offen offset:1024  lds
s_add_u32 m0, s40, 110592
s_nop 0
buffer_load_dwordx4 v19, s[36:39], s47 offen  lds
v_mfma_f32_16x16x32_bf16 v[72:75], v[112:115], v[144:147], v[72:75]
ds_read_b64_tr_b16 v[122:123], v50 offset:1152
ds_read_b64_tr_b16 v[124:125], v50 offset:32
v_mfma_f32_16x16x32_bf16 v[76:79], v[116:119], v[144:147], v[76:79]
ds_read_b64_tr_b16 v[126:127], v50 offset:1184
s_waitcnt lgkmcnt(8)
v_mfma_f32_16x16x32_bf16 v[80:83], v[112:115], v[148:151], v[80:83]
ds_read_b64_tr_b16 v[128:129], v50 offset:64
ds_read_b64_tr_b16 v[130:131], v50 offset:1216
v_mfma_f32_16x16x32_bf16 v[84:87], v[116:119], v[148:151], v[84:87]
ds_read_b64_tr_b16 v[132:133], v51 offset:0
v_mfma_f32_16x16x32_bf16 v[88:91], v[112:115], v[152:155], v[88:91]
ds_read_b64_tr_b16 v[134:135], v51 offset:1152
ds_read_b64_tr_b16 v[136:137], v51 offset:32
v_mfma_f32_16x16x32_bf16 v[92:95], v[116:119], v[152:155], v[92:95]
ds_read_b64_tr_b16 v[138:139], v51 offset:1184
s_waitcnt lgkmcnt(12)
v_mfma_f32_16x16x32_bf16 v[96:99], v[112:115], v[156:159], v[96:99]
v_mfma_f32_16x16x32_bf16 v[100:103], v[116:119], v[156:159], v[100:103]
s_waitcnt lgkmcnt(6)
v_mfma_f32_16x16x32_bf16 v[64:67], v[104:107], v[120:123], v[64:67]
ds_read_b128 v[112:115], v49 offset:0
ds_read_b128 v[116:119], v49 offset:2048
v_mfma_f32_16x16x32_bf16 v[68:71], v[108:111], v[120:123], v[68:71]
ds_read_b64_tr_b16 v[140:141], v50 offset:9728
v_mfma_f32_16x16x32_bf16 v[72:75], v[104:107], v[124:127], v[72:75]
ds_read_b64_tr_b16 v[142:143], v50 offset:10880
ds_read_b64_tr_b16 v[144:145], v50 offset:9760
v_mfma_f32_16x16x32_bf16 v[76:79], v[108:111], v[124:127], v[76:79]
ds_read_b64_tr_b16 v[146:147], v50 offset:10912
s_waitcnt lgkmcnt(8)
v_mfma_f32_16x16x32_bf16 v[80:83], v[104:107], v[128:131], v[80:83]
ds_read_b64_tr_b16 v[148:149], v50 offset:9792
ds_read_b64_tr_b16 v[150:151], v50 offset:10944
v_mfma_f32_16x16x32_bf16 v[84:87], v[108:111], v[128:131], v[84:87]
ds_read_b64_tr_b16 v[152:153], v51 offset:9728
v_mfma_f32_16x16x32_bf16 v[88:91], v[104:107], v[132:135], v[88:91]
ds_read_b64_tr_b16 v[154:155], v51 offset:10880
ds_read_b64_tr_b16 v[156:157], v51 offset:9760
v_mfma_f32_16x16x32_bf16 v[92:95], v[108:111], v[132:135], v[92:95]
ds_read_b64_tr_b16 v[158:159], v51 offset:10912
s_waitcnt lgkmcnt(12)
v_mfma_f32_16x16x32_bf16 v[96:99], v[104:107], v[136:139], v[96:99]
v_mfma_f32_16x16x32_bf16 v[100:103], v[108:111], v[136:139], v[100:103]
s_waitcnt vmcnt(5)
s_barrier
s_waitcnt lgkmcnt(6)
v_mfma_f32_16x16x32_bf16 v[64:67], v[112:115], v[140:143], v[64:67]
ds_read_b128 v[104:107], v52 offset:0
ds_read_b128 v[108:111], v52 offset:2048
v_mfma_f32_16x16x32_bf16 v[68:71], v[116:119], v[140:143], v[68:71]
ds_read_b64_tr_b16 v[120:121], v54 offset:0
s_add_u32 m0, s44, 0
s_mul_i32 s47, s80, 1728
buffer_load_dwordx4 v16, s[32:35], s80 offen  lds
buffer_load_dwordx4 v22, s[32:35], s80 offen offset:1024  lds
s_add_u32 m0, s45, 0
s_nop 0
buffer_load_dwordx4 v17, s[36:39], s47 offen  lds
buffer_load_dwordx4 v18, s[36:39], s47 offen offset:1024  lds
s_add_u32 m0, s40, 0
s_nop 0
buffer_load_dwordx4 v19, s[36:39], s47 offen  lds
v_mfma_f32_16x16x32_bf16 v[72:75], v[112:115], v[144:147], v[72:75]
ds_read_b64_tr_b16 v[122:123], v54 offset:1152
ds_read_b64_tr_b16 v[124:125], v54 offset:32
v_mfma_f32_16x16x32_bf16 v[76:79], v[116:119], v[144:147], v[76:79]
ds_read_b64_tr_b16 v[126:127], v54 offset:1184
s_waitcnt lgkmcnt(8)
v_mfma_f32_16x16x32_bf16 v[80:83], v[112:115], v[148:151], v[80:83]
ds_read_b64_tr_b16 v[128:129], v54 offset:64
ds_read_b64_tr_b16 v[130:131], v54 offset:1216
v_mfma_f32_16x16x32_bf16 v[84:87], v[116:119], v[148:151], v[84:87]
ds_read_b64_tr_b16 v[132:133], v55 offset:0
v_mfma_f32_16x16x32_bf16 v[88:91], v[112:115], v[152:155], v[88:91]
ds_read_b64_tr_b16 v[134:135], v55 offset:1152
ds_read_b64_tr_b16 v[136:137], v55 offset:32
v_mfma_f32_16x16x32_bf16 v[92:95], v[116:119], v[152:155], v[92:95]
ds_read_b64_tr_b16 v[138:139], v55 offset:1184
s_waitcnt lgkmcnt(12)
v_mfma_f32_16x16x32_bf16 v[96:99], v[112:115], v[156:159], v[96:99]
v_mfma_f32_16x16x32_bf16 v[100:103], v[116:119], v[156:159], v[100:103]
s_waitcnt lgkmcnt(6)
v_mfma_f32_16x16x32_bf16 v[64:67], v[104:107], v[120:123], v[64:67]
ds_read_b128 v[112:115], v53 offset:0
ds_read_b128 v[116:119], v53 offset:2048
v_mfma_f32_16x16x32_bf16 v[68:71], v[108:111], v[120:123], v[68:71]
ds_read_b64_tr_b16 v[140:141], v54 offset:9728
v_mfma_f32_16x16x32_bf16 v[72:75], v[104:107], v[124:127], v[72:75]
ds_read_b64_tr_b16 v[142:143], v54 offset:10880
ds_read_b64_tr_b16 v[144:145], v54 offset:9760
v_mfma_f32_16x16x32_bf16 v[76:79], v[108:111], v[124:127], v[76:79]
ds_read_b64_tr_b16 v[146:147], v54 offset:10912
s_waitcnt lgkmcnt(8)
v_mfma_f32_16x16x32_bf16 v[80:83], v[104:107], v[128:131], v[80:83]
ds_read_b64_tr_b16 v[148:149], v54 offset:9792
ds_read_b64_tr_b16 v[150:151], v54 offset:10944
v_mfma_f32_16x16x32_bf16 v[84:87], v[108:111], v[128:131], v[84:87]
ds_read_b64_tr_b16 v[152:153], v55 offset:9728
v_mfma_f32_16x16x32_bf16 v[88:91], v[104:107], v[132:135], v[88:91]
ds_read_b64_tr_b16 v[154:155], v55 offset:10880
ds_read_b64_tr_b16 v[156:157], v55 offset:9760
v_mfma_f32_16x16x32_bf16 v[92:95], v[108:111], v[132:135], v[92:95]
ds_read_b64_tr_b16 v[158:159], v55 offset:10912
s_waitcnt lgkmcnt(12)
v_mfma_f32_16x16x32_bf16 v[96:99], v[104:107], v[136:139], v[96:99]
v_mfma_f32_16x16x32_bf16 v[100:103], v[108:111], v[136:139], v[100:103]
s_waitcnt vmcnt(5)
s_barrier
s_waitcnt lgkmcnt(6)
v_mfma_f32_16x16x32_bf16 v[64:67], v[112:115], v[140:143], v[64:67]
ds_read_b128 v[104:107], v56 offset:0
ds_read_b128 v[108:111], v56 offset:2048
v_mfma_f32_16x16x32_bf16 v[68:71], v[116:119], v[140:143], v[68:71]
ds_read_b64_tr_b16 v[120:121], v58 offset:0
s_add_u32 m0, s44, 36864
s_mul_i32 s47, s81, 1728
buffer_load_dwordx4 v16, s[32:35], s81 offen  lds
buffer_load_dwordx4 v22, s[32:35], s81 offen offset:1024  lds
s_add_u32 m0, s45, 36864
s_nop 0
buffer_load_dwordx4 v17, s[36:39], s47 offen  lds
buffer_load_dwordx4 v18, s[36:39], s47 offen offset:1024  lds
s_add_u32 m0, s40, 36864
s_nop 0
buffer_load_dwordx4 v19, s[36:39], s47 offen  lds
v_mfma_f32_16x16x32_bf16 v[72:75], v[112:115], v[144:147], v[72:75]
ds_read_b64_tr_b16 v[122:123], v58 offset:1152
ds_read_b64_tr_b16 v[124:125], v58 offset:32
v_mfma_f32_16x16x32_bf16 v[76:79], v[116:119], v[144:147], v[76:79]
ds_read_b64_tr_b16 v[126:127], v58 offset:1184
s_waitcnt lgkmcnt(8)
v_mfma_f32_16x16x32_bf16 v[80:83], v[112:115], v[148:151], v[80:83]
ds_read_b64_tr_b16 v[128:129], v58 offset:64
ds_read_b64_tr_b16 v[130:131], v58 offset:1216
v_mfma_f32_16x16x32_bf16 v[84:87], v[116:119], v[148:151], v[84:87]
ds_read_b64_tr_b16 v[132:133], v59 offset:0
v_mfma_f32_16x16x32_bf16 v[88:91], v[112:115], v[152:155], v[88:91]
ds_read_b64_tr_b16 v[134:135], v59 offset:1152
ds_read_b64_tr_b16 v[136:137], v59 offset:32
v_mfma_f32_16x16x32_bf16 v[92:95], v[116:119], v[152:155], v[92:95]
ds_read_b64_tr_b16 v[138:139], v59 offset:1184
s_waitcnt lgkmcnt(12)
v_mfma_f32_16x16x32_bf16 v[96:99], v[112:115], v[156:159], v[96:99]
v_mfma_f32_16x16x32_bf16 v[100:103], v[116:119], v[156:159], v[100:103]
s_waitcnt lgkmcnt(6)
v_mfma_f32_16x16x32_bf16 v[64:67], v[104:107], v[120:123], v[64:67]
ds_read_b128 v[112:115], v57 offset:0
ds_read_b128 v[116:119], v57 offset:2048
v_mfma_f32_16x16x32_bf16 v[68:71], v[108:111], v[120:123], v[68:71]
ds_read_b64_tr_b16 v[140:141], v58 offset:9728
v_mfma_f32_16x16x32_bf16 v[72:75], v[104:107], v[124:127], v[72:75]
ds_read_b64_tr_b16 v[142:143], v58 offset:10880
ds_read_b64_tr_b16 v[144:145], v58 offset:9760
v_mfma_f32_16x16x32_bf16 v[76:79], v[108:111], v[124:127], v[76:79]
ds_read_b64_tr_b16 v[146:147], v58 offset:10912
s_waitcnt lgkmcnt(8)
v_mfma_f32_16x16x32_bf16 v[80:83], v[104:107], v[128:131], v[80:83]
ds_read_b64_tr_b16 v[148:149], v58 offset:9792
ds_read_b64_tr_b16 v[150:151], v58 offset:10944
v_mfma_f32_16x16x32_bf16 v[84:87], v[108:111], v[128:131], v[84:87]
ds_read_b64_tr_b16 v[152:153], v59 offset:9728
v_mfma_f32_16x16x32_bf16 v[88:91], v[104:107], v[132:135], v[88:91]
ds_read_b64_tr_b16 v[154:155], v59 offset:10880
ds_read_b64_tr_b16 v[156:157], v59 offset:9760
v_mfma_f32_16x16x32_bf16 v[92:95], v[108:111], v[132:135], v[92:95]
ds_read_b64_tr_b16 v[158:159], v59 offset:10912
s_waitcnt lgkmcnt(12)
v_mfma_f32_16x16x32_bf16 v[96:99], v[104:107], v[136:139], v[96:99]
v_mfma_f32_16x16x32_bf16 v[100:103], v[108:111], v[136:139], v[100:103]
s_waitcnt vmcnt(5)
s_barrier
s_waitcnt lgkmcnt(6)
v_mfma_f32_16x16x32_bf16 v[64:67], v[112:115], v[140:143], v[64:67]
ds_read_b128 v[104:107], v44 offset:0
ds_read_b128 v[108:111], v44 offset:2048
v_mfma_f32_16x16x32_bf16 v[68:71], v[116:119], v[140:143], v[68:71]
ds_read_b64_tr_b16 v[120:121], v46 offset:0
s_add_u32 m0, s44, 73728
s_mul_i32 s47, s82, 1728
buffer_load_dwordx4 v16, s[32:35], s82 offen  lds
buffer_load_dwordx4 v22, s[32:35], s82 offen offset:1024  lds
s_add_u32 m0, s45, 73728
s_nop 0
buffer_load_dwordx4 v17, s[36:39], s47 offen  lds
buffer_load_dwordx4 v18, s[36:39], s47 offen offset:1024  lds
s_add_u32 m0, s40, 73728
s_nop 0
buffer_load_dwordx4 v19, s[36:39], s47 offen  lds
s_mov_b32 s60, s24
s_mov_b32 s61, s25
s_mov_b32 s62, 0x100
s_mov_b32 s63, 0x20000
v_mov_b32 v240, 0
buffer_load_dword v239, v240, s[60:63], 0 offen sc1
v_mfma_f32_16x16x32_bf16 v[72:75], v[112:115], v[144:147], v[72:75]
ds_read_b64_tr_b16 v[122:123], v46 offset:1152
ds_read_b64_tr_b16 v[124:125], v46 offset:32
v_mfma_f32_16x16x32_bf16 v[76:79], v[116:119], v[144:147], v[76:79]
ds_read_b64_tr_b16 v[126:127], v46 offset:1184
s_waitcnt lgkmcnt(8)
v_mfma_f32_16x16x32_bf16 v[80:83], v[112:115], v[148:151], v[80:83]
ds_read_b64_tr_b16 v[128:129], v46 offset:64
ds_read_b64_tr_b16 v[130:131], v46 offset:1216
v_mfma_f32_16x16x32_bf16 v[84:87], v[116:119], v[148:151], v[84:87]
ds_read_b64_tr_b16 v[132:133], v47 offset:0
v_mfma_f32_16x16x32_bf16 v[88:91], v[112:115], v[152:155], v[88:91]
ds_read_b64_tr_b16 v[134:135], v47 offset:1152
ds_read_b64_tr_b16 v[136:137], v47 offset:32
v_mfma_f32_16x16x32_bf16 v[92:95], v[116:119], v[152:155], v[92:95]
ds_read_b64_tr_b16 v[138:139], v47 offset:1184
s_waitcnt lgkmcnt(12)
v_mfma_f32_16x16x32_bf16 v[96:99], v[112:115], v[156:159], v[96:99]
v_mfma_f32_16x16x32_bf16 v[100:103], v[116:119], v[156:159], v[100:103]
s_waitcnt lgkmcnt(6)
v_mfma_f32_16x16x32_bf16 v[64:67], v[104:107], v[120:123], v[64:67]
ds_read_b128 v[112:115], v45 offset:0
ds_read_b128 v[116:119], v45 offset:2048
v_mfma_f32_16x16x32_bf16 v[68:71], v[108:111], v[120:123], v[68:71]
ds_read_b64_tr_b16 v[140:141], v46 offset:9728
v_mfma_f32_16x16x32_bf16 v[72:75], v[104:107], v[124:127], v[72:75]
ds_read_b64_tr_b16 v[142:143], v46 offset:10880
ds_read_b64_tr_b16 v[144:145], v46 offset:9760
v_mfma_f32_16x16x32_bf16 v[76:79], v[108:111], v[124:127], v[76:79]
ds_read_b64_tr_b16 v[146:147], v46 offset:10912
s_waitcnt lgkmcnt(8)
v_mfma_f32_16x16x32_bf16 v[80:83], v[104:107], v[128:131], v[80:83]
ds_read_b64_tr_b16 v[148:149], v46 offset:9792
ds_read_b64_tr_b16 v[150:151], v46 offset:10944
v_mfma_f32_16x16x32_bf16 v[84:87], v[108:111], v[128:131], v[84:87]
ds_read_b64_tr_b16 v[152:153], v47 offset:9728
v_mfma_f32_16x16x32_bf16 v[88:91], v[104:107], v[132:135], v[88:91]
ds_read_b64_tr_b16 v[154:155], v47 offset:10880
ds_read_b64_tr_b16 v[156:157], v47 offset:9760
v_mfma_f32_16x16x32_bf16 v[92:95], v[108:111], v[132:135], v[92:95]
ds_read_b64_tr_b16 v[158:159], v47 offset:10912
s_waitcnt lgkmcnt(12)
v_mfma_f32_16x16x32_bf16 v[96:99], v[104:107], v[136:139], v[96:99]
v_mfma_f32_16x16x32_bf16 v[100:103], v[108:111], v[136:139], v[100:103]
s_waitcnt vmcnt(6)
s_barrier
s_waitcnt lgkmcnt(6)
v_mfma_f32_16x16x32_bf16 v[64:67], v[112:115], v[140:143], v[64:67]
ds_read_b128 v[104:107], v48 offset:0
ds_read_b128 v[108:111], v48 offset:2048
v_mfma_f32_16x16x32_bf16 v[68:71], v[116:119], v[140:143], v[68:71]
ds_read_b64_tr_b16 v[120:121], v50 offset:0
s_add_u32 m0, s44, 110592
s_mul_i32 s47, s83, 1728
buffer_load_dwordx4 v16, s[32:35], s83 offen  lds
buffer_load_dwordx4 v22, s[32:35], s83 offen offset:1024  lds
s_add_u32 m0, s45, 110592
s_nop 0
buffer_load_dwordx4 v17, s[36:39], s47 offen  lds
buffer_load_dwordx4 v18, s[36:39], s47 offen offset:1024  lds
s_add_u32 m0, s40, 110592
s_nop 0
buffer_load_dwordx4 v19, s[36:39], s47 offen  lds
v_mfma_f32_16x16x32_bf16 v[72:75], v[112:115], v[144:147], v[72:75]
ds_read_b64_tr_b16 v[122:123], v50 offset:1152
ds_read_b64_tr_b16 v[124:125], v50 offset:32
v_mfma_f32_16x16x32_bf16 v[76:79], v[116:119], v[144:147], v[76:79]
ds_read_b64_tr_b16 v[126:127], v50 offset:1184
s_waitcnt lgkmcnt(8)
v_mfma_f32_16x16x32_bf16 v[80:83], v[112:115], v[148:151], v[80:83]
ds_read_b64_tr_b16 v[128:129], v50 offset:64
ds_read_b64_tr_b16 v[130:131], v50 offset:1216
v_mfma_f32_16x16x32_bf16 v[84:87], v[116:119], v[148:151], v[84:87]
ds_read_b64_tr_b16 v[132:133], v51 offset:0
v_mfma_f32_16x16x32_bf16 v[88:91], v[112:115], v[152:155], v[88:91]
ds_read_b64_tr_b16 v[134:135], v51 offset:1152
ds_read_b64_tr_b16 v[136:137], v51 offset:32
v_mfma_f32_16x16x32_bf16 v[92:95], v[116:119], v[152:155], v[92:95]
ds_read_b64_tr_b16 v[138:139], v51 offset:1184
s_waitcnt lgkmcnt(12)
v_mfma_f32_16x16x32_bf16 v[96:99], v[112:115], v[156:159], v[96:99]
v_mfma_f32_16x16x32_bf16 v[100:103], v[116:119], v[156:159], v[100:103]
s_waitcnt lgkmcnt(6)
v_mfma_f32_16x16x32_bf16 v[64:67], v[104:107], v[120:123], v[64:67]
ds_read_b128 v[112:115], v49 offset:0
ds_read_b128 v[116:119], v49 offset:2048
v_mfma_f32_16x16x32_bf16 v[68:71], v[108:111], v[120:123], v[68:71]
ds_read_b64_tr_b16 v[140:141], v50 offset:9728
v_mfma_f32_16x16x32_bf16 v[72:75], v[104:107], v[124:127], v[72:75]
ds_read_b64_tr_b16 v[142:143], v50 offset:10880
ds_read_b64_tr_b16 v[144:145], v50 offset:9760
v_mfma_f32_16x16x32_bf16 v[76:79], v[108:111], v[124:127], v[76:79]
ds_read_b64_tr_b16 v[146:147], v50 offset:10912
s_waitcnt lgkmcnt(8)
v_mfma_f32_16x16x32_bf16 v[80:83], v[104:107], v[128:131], v[80:83]
ds_read_b64_tr_b16 v[148:149], v50 offset:9792
ds_read_b64_tr_b16 v[150:151], v50 offset:10944
v_mfma_f32_16x16x32_bf16 v[84:87], v[108:111], v[128:131], v[84:87]
ds_read_b64_tr_b16 v[152:153], v51 offset:9728
v_mfma_f32_16x16x32_bf16 v[88:91], v[104:107], v[132:135], v[88:91]
ds_read_b64_tr_b16 v[154:155], v51 offset:10880
ds_read_b64_tr_b16 v[156:157], v51 offset:9760
v_mfma_f32_16x16x32_bf16 v[92:95], v[108:111], v[132:135], v[92:95]
ds_read_b64_tr_b16 v[158:159], v51 offset:10912
s_waitcnt lgkmcnt(12)
v_mfma_f32_16x16x32_bf16 v[96:99], v[104:107], v[136:139], v[96:99]
v_mfma_f32_16x16x32_bf16 v[100:103], v[108:111], v[136:139], v[100:103]
s_waitcnt vmcnt(6)
s_barrier
s_waitcnt lgkmcnt(6)
v_mfma_f32_16x16x32_bf16 v[64:67], v[112:115], v[140:143], v[64:67]
ds_read_b128 v[104:107], v52 offset:0
ds_read_b128 v[108:111], v52 offset:2048
v_mfma_f32_16x16x32_bf16 v[68:71], v[116:119], v[140:143], v[68:71]
ds_read_b64_tr_b16 v[120:121], v54 offset:0
s_add_u32 m0, s44, 0
s_mul_i32 s47, s84, 1728
buffer_load_dwordx4 v16, s[32:35], s84 offen  lds
buffer_load_dwordx4 v22, s[32:35], s84 offen offset:1024  lds
s_add_u32 m0, s45, 0
s_nop 0
buffer_load_dwordx4 v17, s[36:39], s47 offen  lds
buffer_load_dwordx4 v18, s[36:39], s47 offen offset:1024  lds
s_add_u32 m0, s40, 0
s_nop 0
buffer_load_dwordx4 v19, s[36:39], s47 offen  lds
v_mfma_f32_16x16x32_bf16 v[72:75], v[112:115], v[144:147], v[72:75]
ds_read_b64_tr_b16 v[122:123], v54 offset:1152
ds_read_b64_tr_b16 v[124:125], v54 offset:32
v_mfma_f32_16x16x32_bf16 v[76:79], v[116:119], v[144:147], v[76:79]
ds_read_b64_tr_b16 v[126:127], v54 offset:1184
s_waitcnt lgkmcnt(8)
v_mfma_f32_16x16x32_bf16 v[80:83], v[112:115], v[148:151], v[80:83]
ds_read_b64_tr_b16 v[128:129], v54 offset:64
ds_read_b64_tr_b16 v[130:131], v54 offset:1216
v_mfma_f32_16x16x32_bf16 v[84:87], v[116:119], v[148:151], v[84:87]
ds_read_b64_tr_b16 v[132:133], v55 offset:0
v_mfma_f32_16x16x32_bf16 v[88:91], v[112:115], v[152:155], v[88:91]
ds_read_b64_tr_b16 v[134:135], v55 offset:1152
ds_read_b64_tr_b16 v[136:137], v55 offset:32
v_mfma_f32_16x16x32_bf16 v[92:95], v[116:119], v[152:155], v[92:95]
ds_read_b64_tr_b16 v[138:139], v55 offset:1184
s_waitcnt lgkmcnt(12)
v_mfma_f32_16x16x32_bf16 v[96:99], v[112:115], v[156:159], v[96:99]
v_mfma_f32_16x16x32_bf16 v[100:103], v[116:119], v[156:159], v[100:103]
s_waitcnt lgkmcnt(6)
v_mfma_f32_16x16x32_bf16 v[64:67], v[104:107], v[120:123], v[64:67]
ds_read_b128 v[112:115], v53 offset:0
ds_read_b128 v[116:119], v53 offset:2048
v_mfma_f32_16x16x32_bf16 v[68:71], v[108:111], v[120:123], v[68:71]
ds_read_b64_tr_b16 v[140:141], v54 offset:9728
v_mfma_f32_16x16x32_bf16 v[72:75], v[104:107], v[124:127], v[72:75]
ds_read_b64_tr_b16 v[142:143], v54 offset:10880
ds_read_b64_tr_b16 v[144:145], v54 offset:9760
v_mfma_f32_16x16x32_bf16 v[76:79], v[108:111], v[124:127], v[76:79]
ds_read_b64_tr_b16 v[146:147], v54 offset:10912
s_waitcnt lgkmcnt(8)
v_mfma_f32_16x16x32_bf16 v[80:83], v[104:107], v[128:131], v[80:83]
ds_read_b64_tr_b16 v[148:149], v54 offset:9792
ds_read_b64_tr_b16 v[150:151], v54 offset:10944
v_mfma_f32_16x16x32_bf16 v[84:87], v[108:111], v[128:131], v[84:87]
ds_read_b64_tr_b16 v[152:153], v55 offset:9728
v_mfma_f32_16x16x32_bf16 v[88:91], v[104:107], v[132:135], v[88:91]
ds_read_b64_tr_b16 v[154:155], v55 offset:10880
ds_read_b64_tr_b16 v[156:157], v55 offset:9760
v_mfma_f32_16x16x32_bf16 v[92:95], v[108:111], v[132:135], v[92:95]
ds_read_b64_tr_b16 v[158:159], v55 offset:10912
s_waitcnt lgkmcnt(12)
v_mfma_f32_16x16x32_bf16 v[96:99], v[104:107], v[136:139], v[96:99]
v_mfma_f32_16x16x32_bf16 v[100:103], v[108:111], v[136:139], v[100:103]
s_waitcnt vmcnt(5)
s_barrier
s_waitcnt lgkmcnt(6)
v_mfma_f32_16x16x32_bf16 v[64:67], v[112:115], v[140:143], v[64:67]
ds_read_b128 v[104:107], v56 offset:0
ds_read_b128 v[108:111], v56 offset:2048
v_mfma_f32_16x16x32_bf16 v[68:71], v[116:119], v[140:143], v[68:71]
ds_read_b64_tr_b16 v[120:121], v58 offset:0
v_mfma_f32_16x16x32_bf16 v[72:75], v[112:115], v[144:147], v[72:75]
ds_read_b64_tr_b16 v[122:123], v58 offset:1152
ds_read_b64_tr_b16 v[124:125], v58 offset:32
v_mfma_f32_16x16x32_bf16 v[76:79], v[116:119], v[144:147], v[76:79]
ds_read_b64_tr_b16 v[126:127], v58 offset:1184
s_waitcnt lgkmcnt(8)
v_mfma_f32_16x16x32_bf16 v[80:83], v[112:115], v[148:151], v[80:83]
ds_read_b64_tr_b16 v[128:129], v58 offset:64
ds_read_b64_tr_b16 v[130:131], v58 offset:1216
v_mfma_f32_16x16x32_bf16 v[84:87], v[116:119], v[148:151], v[84:87]
ds_read_b64_tr_b16 v[132:133], v59 offset:0
v_mfma_f32_16x16x32_bf16 v[88:91], v[112:115], v[152:155], v[88:91]
ds_read_b64_tr_b16 v[134:135], v59 offset:1152
ds_read_b64_tr_b16 v[136:137], v59 offset:32
v_mfma_f32_16x16x32_bf16 v[92:95], v[116:119], v[152:155], v[92:95]
ds_read_b64_tr_b16 v[138:139], v59 offset:1184
s_waitcnt lgkmcnt(12)
v_mfma_f32_16x16x32_bf16 v[96:99], v[112:115], v[156:159], v[96:99]
v_mfma_f32_16x16x32_bf16 v[100:103], v[116:119], v[156:159], v[100:103]
s_waitcnt lgkmcnt(6)
v_mfma_f32_16x16x32_bf16 v[64:67], v[104:107], v[120:123], v[64:67]
ds_read_b128 v[112:115], v57 offset:0
ds_read_b128 v[116:119], v57 offset:2048
v_mfma_f32_16x16x32_bf16 v[68:71], v[108:111], v[120:123], v[68:71]
ds_read_b64_tr_b16 v[140:141], v58 offset:9728
v_mfma_f32_16x16x32_bf16 v[72:75], v[104:107], v[124:127], v[72:75]
ds_read_b64_tr_b16 v[142:143], v58 offset:10880
ds_read_b64_tr_b16 v[144:145], v58 offset:9760
v_mfma_f32_16x16x32_bf16 v[76:79], v[108:111], v[124:127], v[76:79]
ds_read_b64_tr_b16 v[146:147], v58 offset:10912
s_waitcnt lgkmcnt(8)
v_mfma_f32_16x16x32_bf16 v[80:83], v[104:107], v[128:131], v[80:83]
ds_read_b64_tr_b16 v[148:149], v58 offset:9792
ds_read_b64_tr_b16 v[150:151], v58 offset:10944
v_mfma_f32_16x16x32_bf16 v[84:87], v[108:111], v[128:131], v[84:87]
ds_read_b64_tr_b16 v[152:153], v59 offset:9728
v_mfma_f32_16x16x32_bf16 v[88:91], v[104:107], v[132:135], v[88:91]
ds_read_b64_tr_b16 v[154:155], v59 offset:10880
ds_read_b64_tr_b16 v[156:157], v59 offset:9760
v_mfma_f32_16x16x32_bf16 v[92:95], v[108:111], v[132:135], v[92:95]
ds_read_b64_tr_b16 v[158:159], v59 offset:10912
s_waitcnt lgkmcnt(12)
v_mfma_f32_16x16x32_bf16 v[96:99], v[104:107], v[136:139], v[96:99]
v_mfma_f32_16x16x32_bf16 v[100:103], v[108:111], v[136:139], v[100:103]
s_waitcnt vmcnt(0)
s_barrier
s_waitcnt lgkmcnt(6)
v_mfma_f32_16x16x32_bf16 v[64:67], v[112:115], v[140:143], v[64:67]
ds_read_b128 v[104:107], v44 offset:0
ds_read_b128 v[108:111], v44 offset:2048
v_mfma_f32_16x16x32_bf16 v[68:71], v[116:119], v[140:143], v[68:71]
ds_read_b64_tr_b16 v[120:121], v46 offset:0
s_lshl_b32 s73, s72, 3
s_add_u32 s73, s73, s71
s_mov_b32 s91, s29
v_readfirstlane_b32 s70, v239
s_nop 0
s_cmp_lg_u32 s70, 0
s_cbranch_scc1 Ltr_4
s_mov_b32 s60, s24
s_mov_b32 s61, s25
s_mov_b32 s62, 0x100
s_mov_b32 s63, 0x20000
v_mov_b32 v240, 0
buffer_load_dword v239, v240, s[60:63], 0 offen sc1
s_waitcnt vmcnt(0)
v_readfirstlane_b32 s70, v239
s_nop 0
s_cmp_lg_u32 s70, 0
s_cbranch_scc1 Lnf_5
s_mov_b32 s60, s24
s_mov_b32 s61, s25
s_mov_b32 s62, 0x100
s_mov_b32 s63, 0x20000
s_mov_b32 s69, 0
v_mov_b32 v240, 0
Lnq_6:
buffer_load_dword v239, v240, s[60:63], 0 offen sc1
s_add_u32 s69, s69, 1
s_waitcnt vmcnt(0)
v_readfirstlane_b32 s70, v239
s_cmp_ge_u32 s69, 100000
s_cbranch_scc1 Lnf_5
s_cmp_eq_u32 s70, 0
s_cbranch_scc1 Lnq_6
Lnf_5:
Ltr_4:
s_mul_i32 s92, s70, 0x9E3779B1
v_mfma_f32_16x16x32_bf16 v[72:75], v[112:115], v[144:147], v[72:75]
ds_read_b64_tr_b16 v[122:123], v46 offset:1152
ds_read_b64_tr_b16 v[124:125], v46 offset:32
v_mfma_f32_16x16x32_bf16 v[76:79], v[116:119], v[144:147], v[76:79]
ds_read_b64_tr_b16 v[126:127], v46 offset:1184
s_min_u32 s93, s73, 115
s_add_u32 s93, s93, 28
s_mov_b32 s29, s93
v_and_b32 v242, 31, v0
s_bfe_u32 s68, s93, 0x10004
s_lshl_b32 s68, s68, 5
s_add_u32 s68, s68, 0
v_add_u32 v242, s68, v242
v_lshlrev_b32 v242, 7, v242
v_add_u32 v242, 10166272, v242
buffer_load_dword v243, v242, s[64:67], 0 offen sc1
s_waitcnt lgkmcnt(8)
v_mfma_f32_16x16x32_bf16 v[80:83], v[112:115], v[148:151], v[80:83]
ds_read_b64_tr_b16 v[128:129], v46 offset:64
ds_read_b64_tr_b16 v[130:131], v46 offset:1216
v_mfma_f32_16x16x32_bf16 v[84:87], v[116:119], v[148:151], v[84:87]
ds_read_b64_tr_b16 v[132:133], v47 offset:0
s_lshr_b32 s41, s28, 1
s_and_b32 s89, s28, 1
s_lshl_b32 s88, s29, 2
s_add_u32 s88, s88, s41
s_mul_i32 s90, s41, 16640
s_add_u32 s90, s90, 55168
s_mul_i32 s94, s41, 4576
s_add_u32 s94, s94, 36864
s_lshl_b32 s42, s88, 12
s_add_u32 s32, s18, s42
s_addc_u32 s33, s19, 0
s_mov_b32 s34, 0x1000
s_mov_b32 s35, 0x20000
s_mov_b32 s36, s20
s_mov_b32 s37, s21
s_mov_b32 s38, 0x480
s_mov_b32 s39, 0x20000
v_lshlrev_b32 v41, 4, v0
s_lshl_b32 s41, s89, 11
v_add_u32 v42, s41, v41
buffer_load_dwordx4 v[28:31], v42, s[32:35], 0 offen nt
v_subrev_u32 v43, 8, v42
buffer_load_dwordx2 v[24:25], v43, s[32:35], 0 offen nt
v_add_u32 v42, 1024, v42
buffer_load_dwordx4 v[36:39], v42, s[32:35], 0 offen nt
v_subrev_u32 v43, 8, v42
buffer_load_dwordx2 v[32:33], v43, s[32:35], 0 offen nt
s_lshl_b32 s41, s88, 1
v_mov_b32 v43, s41
buffer_load_ushort v40, v43, s[36:39], 0 offen
s_mov_b32 s29, s91
v_mfma_f32_16x16x32_bf16 v[88:91], v[112:115], v[152:155], v[88:91]
ds_read_b64_tr_b16 v[134:135], v47 offset:1152
ds_read_b64_tr_b16 v[136:137], v47 offset:32
v_mfma_f32_16x16x32_bf16 v[92:95], v[116:119], v[152:155], v[92:95]
ds_read_b64_tr_b16 v[138:139], v47 offset:1184
s_mov_b32 s56, 0x3fb8aa3b
s_mov_b32 s57, 0x3fb8aa3b
s_mov_b32 s58, 0x358637bd
s_mov_b32 s59, 0x358637bd
s_and_b32 s41, s28, 3
s_mul_i32 s41, s41, 10240
s_lshr_b32 s42, s28, 2
s_mul_i32 s43, s42, 5120
s_add_u32 s41, s41, s43
s_add_u32 s41, s41, 122880
v_lshlrev_b32 v2, 4, v0
v_add_u32 v3, s41, v2
s_mov_b32 s48, s42
s_mov_b32 s41, 0x01000100
s_cmp_eq_u32 s48, 0
s_cselect_b32 s60, 0, s41
s_mov_b32 s61, s60
s_lshl_b32 s41, s28, 2
s_lshr_b32 s62, 0x65454343, s41
s_and_b32 s62, s62, 15
s_lshl_b32 s62, s62, 10
s_add_u32 s62, s62, 122880
s_lshr_b32 s63, 0x22211100, s41
s_and_b32 s63, s63, 15
s_lshl_b32 s63, s63, 10
s_add_u32 s63, s63, 122880
v_add_u32 v4, s62, v2
v_add_u32 v5, s63, v2
s_lshr_b32 s62, 0x77776765, s41
s_and_b32 s62, s62, 15
s_lshl_b32 s62, s62, 10
s_add_u32 s62, s62, 122880
s_lshr_b32 s63, 0x21099888, s41
s_and_b32 s63, s63, 15
s_lshl_b32 s63, s63, 10
s_add_u32 s63, s63, 122880
v_add_u32 v6, s62, v2
v_add_u32 v7, s63, v2
s_lshl_b32 s41, s30, 4
s_add_u32 s41, s41, s91
s_mul_i32 s41, s41, 16896
s_add_u32 s49, s41, 4718592
s_lshl_b32 s42, s28, 10
s_add_u32 s50, s42, s49
s_lshl_b32 s62, s28, 2
s_lshr_b32 s62, 0x32150400, s62
s_and_b32 s51, s62, 15
s_sub_u32 s62, s51, 1
s_lshl_b32 s62, s62, 6
s_add_u32 s62, s62, s49
s_add_u32 s62, s62, 16256
v_mov_b32 v172, 0xffffff00
v_bfe_u32 v168, s92, 0, 8
v_bfe_u32 v169, s92, 8, 8
v_bfe_u32 v170, s92, 16, 8
v_bfe_u32 v171, s92, 24, 8
v_mov_b32 v8, 0x3f803f80
v_lshlrev_b32 v9, 2, v0
s_waitcnt lgkmcnt(12)
v_mfma_f32_16x16x32_bf16 v[96:99], v[112:115], v[156:159], v[96:99]
v_mfma_f32_16x16x32_bf16 v[100:103], v[116:119], v[156:159], v[100:103]
s_waitcnt lgkmcnt(6)
v_mfma_f32_16x16x32_bf16 v[64:67], v[104:107], v[120:123], v[64:67]
ds_read_b128 v[112:115], v45 offset:0
ds_read_b128 v[116:119], v45 offset:2048
v_mfma_f32_16x16x32_bf16 v[68:71], v[108:111], v[120:123], v[68:71]
ds_read_b64_tr_b16 v[140:141], v46 offset:9728
v_mfma_f32_16x16x32_bf16 v[72:75], v[104:107], v[124:127], v[72:75]
ds_read_b64_tr_b16 v[142:143], v46 offset:10880
ds_read_b64_tr_b16 v[144:145], v46 offset:9760
v_mfma_f32_16x16x32_bf16 v[76:79], v[108:111], v[124:127], v[76:79]
ds_read_b64_tr_b16 v[146:147], v46 offset:10912
s_waitcnt lgkmcnt(8)
v_mfma_f32_16x16x32_bf16 v[80:83], v[104:107], v[128:131], v[80:83]
ds_read_b64_tr_b16 v[148:149], v46 offset:9792
ds_read_b64_tr_b16 v[150:151], v46 offset:10944
v_mfma_f32_16x16x32_bf16 v[84:87], v[108:111], v[128:131], v[84:87]
ds_read_b64_tr_b16 v[152:153], v47 offset:9728
v_mfma_f32_16x16x32_bf16 v[88:91], v[104:107], v[132:135], v[88:91]
ds_read_b64_tr_b16 v[154:155], v47 offset:10880
ds_read_b64_tr_b16 v[156:157], v47 offset:9760
v_mfma_f32_16x16x32_bf16 v[92:95], v[108:111], v[132:135], v[92:95]
ds_read_b64_tr_b16 v[158:159], v47 offset:10912
s_waitcnt lgkmcnt(12)
v_mfma_f32_16x16x32_bf16 v[96:99], v[104:107], v[136:139], v[96:99]
v_mfma_f32_16x16x32_bf16 v[100:103], v[108:111], v[136:139], v[100:103]
s_waitcnt lgkmcnt(6)
v_mfma_f32_16x16x32_bf16 v[64:67], v[112:115], v[140:143], v[64:67]
v_mfma_f32_16x16x32_bf16 v[68:71], v[116:119], v[140:143], v[68:71]
v_mfma_f32_16x16x32_bf16 v[72:75], v[112:115], v[144:147], v[72:75]
v_mfma_f32_16x16x32_bf16 v[76:79], v[116:119], v[144:147], v[76:79]
s_waitcnt lgkmcnt(2)
v_mfma_f32_16x16x32_bf16 v[80:83], v[112:115], v[148:151], v[80:83]
v_mfma_f32_16x16x32_bf16 v[84:87], v[116:119], v[148:151], v[84:87]
v_mfma_f32_16x16x32_bf16 v[88:91], v[112:115], v[152:155], v[88:91]
v_mfma_f32_16x16x32_bf16 v[92:95], v[116:119], v[152:155], v[92:95]
s_waitcnt lgkmcnt(0)
v_mfma_f32_16x16x32_bf16 v[96:99], v[112:115], v[156:159], v[96:99]
v_mfma_f32_16x16x32_bf16 v[100:103], v[116:119], v[156:159], v[100:103]
s_cmp_ge_u32 s73, 116
s_cbranch_scc1 concat_heads__linear_attn_block__ssm_conv_h3__prompt_kernel_kvnoconv
s_waitcnt vmcnt(5)
v_cmp_ne_u32 vcc, s70, v243
s_nop 0
s_cmp_eq_u64 vcc, 0
s_cselect_b32 s95, 1, 0
s_cbranch_scc0 Llate_8
v_lshlrev_b32 v41, 4, v0
s_lshl_b32 s41, s88, 12
s_lshl_b32 s42, s89, 11
s_add_u32 s41, s41, s42
s_add_u32 s41, s41, 0
s_add_u32 s42, s42, s94
s_add_u32 m0, s42, 480
s_add_u32 s43, s41, 0
buffer_load_dwordx4 v41, s[64:67], s43 offen sc1 lds
s_add_u32 m0, s42, 1504
s_add_u32 s43, s41, 1024
buffer_load_dwordx4 v41, s[64:67], s43 offen sc1 lds
s_branch Lgo_10
Llate_8:
buffer_load_dword v243, v242, s[64:67], 0 offen sc1
Lgo_10:
s_cmp_eq_u32 s48, 0
s_cbranch_scc0 Lkvb_11
v_pk_mul_f32 v[104:105], v[64:65], s[56:57]
v_pk_mul_f32 v[106:107], v[66:67], s[56:57]
v_pk_mul_f32 v[108:109], v[68:69], s[56:57]
v_pk_mul_f32 v[110:111], v[70:71], s[56:57]
v_exp_f32 v104, v104 clamp
v_exp_f32 v105, v105 clamp
v_exp_f32 v106, v106 clamp
v_exp_f32 v107, v107 clamp
v_exp_f32 v108, v108 clamp
v_exp_f32 v109, v109 clamp
v_exp_f32 v110, v110 clamp
v_exp_f32 v111, v111 clamp
v_max_f32 v64, 0, v64
v_max_f32 v65, 0, v65
v_max_f32 v66, 0, v66
v_max_f32 v67, 0, v67
v_max_f32 v68, 0, v68
v_max_f32 v69, 0, v69
v_max_f32 v70, 0, v70
v_max_f32 v71, 0, v71
v_pk_add_f32 v[104:105], v[104:105], s[58:59]
v_pk_add_f32 v[106:107], v[106:107], s[58:59]
v_pk_add_f32 v[108:109], v[108:109], s[58:59]
v_pk_add_f32 v[110:111], v[110:111], s[58:59]
v_pk_add_f32 v[64:65], v[64:65], v[104:105]
v_pk_add_f32 v[66:67], v[66:67], v[106:107]
v_pk_add_f32 v[68:69], v[68:69], v[108:109]
v_pk_add_f32 v[70:71], v[70:71], v[110:111]
v_pk_mul_f32 v[104:105], v[72:73], s[56:57]
v_pk_mul_f32 v[106:107], v[74:75], s[56:57]
v_pk_mul_f32 v[108:109], v[76:77], s[56:57]
v_pk_mul_f32 v[110:111], v[78:79], s[56:57]
v_exp_f32 v104, v104 clamp
v_exp_f32 v105, v105 clamp
v_exp_f32 v106, v106 clamp
v_exp_f32 v107, v107 clamp
v_exp_f32 v108, v108 clamp
v_exp_f32 v109, v109 clamp
v_exp_f32 v110, v110 clamp
v_exp_f32 v111, v111 clamp
v_max_f32 v72, 0, v72
v_max_f32 v73, 0, v73
v_max_f32 v74, 0, v74
v_max_f32 v75, 0, v75
v_max_f32 v76, 0, v76
v_max_f32 v77, 0, v77
v_max_f32 v78, 0, v78
v_max_f32 v79, 0, v79
v_pk_add_f32 v[104:105], v[104:105], s[58:59]
v_pk_add_f32 v[106:107], v[106:107], s[58:59]
v_pk_add_f32 v[108:109], v[108:109], s[58:59]
v_pk_add_f32 v[110:111], v[110:111], s[58:59]
v_pk_add_f32 v[72:73], v[72:73], v[104:105]
v_pk_add_f32 v[74:75], v[74:75], v[106:107]
v_pk_add_f32 v[76:77], v[76:77], v[108:109]
v_pk_add_f32 v[78:79], v[78:79], v[110:111]
v_pk_mul_f32 v[104:105], v[80:81], s[56:57]
v_pk_mul_f32 v[106:107], v[82:83], s[56:57]
v_pk_mul_f32 v[108:109], v[84:85], s[56:57]
v_pk_mul_f32 v[110:111], v[86:87], s[56:57]
v_exp_f32 v104, v104 clamp
v_exp_f32 v105, v105 clamp
v_exp_f32 v106, v106 clamp
v_exp_f32 v107, v107 clamp
v_exp_f32 v108, v108 clamp
v_exp_f32 v109, v109 clamp
v_exp_f32 v110, v110 clamp
v_exp_f32 v111, v111 clamp
v_max_f32 v80, 0, v80
v_max_f32 v81, 0, v81
v_max_f32 v82, 0, v82
v_max_f32 v83, 0, v83
v_max_f32 v84, 0, v84
v_max_f32 v85, 0, v85
v_max_f32 v86, 0, v86
v_max_f32 v87, 0, v87
v_pk_add_f32 v[104:105], v[104:105], s[58:59]
v_pk_add_f32 v[106:107], v[106:107], s[58:59]
v_pk_add_f32 v[108:109], v[108:109], s[58:59]
v_pk_add_f32 v[110:111], v[110:111], s[58:59]
v_pk_add_f32 v[80:81], v[80:81], v[104:105]
v_pk_add_f32 v[82:83], v[82:83], v[106:107]
v_pk_add_f32 v[84:85], v[84:85], v[108:109]
v_pk_add_f32 v[86:87], v[86:87], v[110:111]
s_branch Lkvc_12
Lkvb_11:
v_pk_mul_f32 v[104:105], v[88:89], s[56:57]
v_pk_mul_f32 v[106:107], v[90:91], s[56:57]
v_pk_mul_f32 v[108:109], v[92:93], s[56:57]
v_pk_mul_f32 v[110:111], v[94:95], s[56:57]
v_exp_f32 v104, v104 clamp
v_exp_f32 v105, v105 clamp
v_exp_f32 v106, v106 clamp
v_exp_f32 v107, v107 clamp
v_exp_f32 v108, v108 clamp
v_exp_f32 v109, v109 clamp
v_exp_f32 v110, v110 clamp
v_exp_f32 v111, v111 clamp
v_max_f32 v88, 0, v88
v_max_f32 v89, 0, v89
v_max_f32 v90, 0, v90
v_max_f32 v91, 0, v91
v_max_f32 v92, 0, v92
v_max_f32 v93, 0, v93
v_max_f32 v94, 0, v94
v_max_f32 v95, 0, v95
v_pk_add_f32 v[104:105], v[104:105], s[58:59]
v_pk_add_f32 v[106:107], v[106:107], s[58:59]
v_pk_add_f32 v[108:109], v[108:109], s[58:59]
v_pk_add_f32 v[110:111], v[110:111], s[58:59]
v_pk_add_f32 v[88:89], v[88:89], v[104:105]
v_pk_add_f32 v[90:91], v[90:91], v[106:107]
v_pk_add_f32 v[92:93], v[92:93], v[108:109]
v_pk_add_f32 v[94:95], v[94:95], v[110:111]
v_pk_mul_f32 v[104:105], v[96:97], s[56:57]
v_pk_mul_f32 v[106:107], v[98:99], s[56:57]
v_pk_mul_f32 v[108:109], v[100:101], s[56:57]
v_pk_mul_f32 v[110:111], v[102:103], s[56:57]
v_exp_f32 v104, v104 clamp
v_exp_f32 v105, v105 clamp
v_exp_f32 v106, v106 clamp
v_exp_f32 v107, v107 clamp
v_exp_f32 v108, v108 clamp
v_exp_f32 v109, v109 clamp
v_exp_f32 v110, v110 clamp
v_exp_f32 v111, v111 clamp
v_max_f32 v96, 0, v96
v_max_f32 v97, 0, v97
v_max_f32 v98, 0, v98
v_max_f32 v99, 0, v99
v_max_f32 v100, 0, v100
v_max_f32 v101, 0, v101
v_max_f32 v102, 0, v102
v_max_f32 v103, 0, v103
v_pk_add_f32 v[104:105], v[104:105], s[58:59]
v_pk_add_f32 v[106:107], v[106:107], s[58:59]
v_pk_add_f32 v[108:109], v[108:109], s[58:59]
v_pk_add_f32 v[110:111], v[110:111], s[58:59]
v_pk_add_f32 v[96:97], v[96:97], v[104:105]
v_pk_add_f32 v[98:99], v[98:99], v[106:107]
v_pk_add_f32 v[100:101], v[100:101], v[108:109]
v_pk_add_f32 v[102:103], v[102:103], v[110:111]
Lkvc_12:
v_cvt_pk_bf16_f32 v120, v64, v65
v_cvt_pk_bf16_f32 v121, v66, v67
v_cvt_pk_bf16_f32 v122, v68, v69
v_cvt_pk_bf16_f32 v123, v70, v71
ds_write_b128 v3, v[120:123] offset:0
v_cvt_pk_bf16_f32 v124, v72, v73
v_cvt_pk_bf16_f32 v125, v74, v75
v_cvt_pk_bf16_f32 v126, v76, v77
v_cvt_pk_bf16_f32 v127, v78, v79
ds_write_b128 v3, v[124:127] offset:1024
v_cvt_pk_bf16_f32 v128, v80, v81
v_cvt_pk_bf16_f32 v129, v82, v83
v_cvt_pk_bf16_f32 v130, v84, v85
v_cvt_pk_bf16_f32 v131, v86, v87
v_cndmask_b32 v128, v128, v8, s[60:61]
v_cndmask_b32 v129, v129, v8, s[60:61]
v_cndmask_b32 v130, v130, v8, s[60:61]
v_cndmask_b32 v131, v131, v8, s[60:61]
ds_write_b128 v3, v[128:131] offset:2048
v_cvt_pk_bf16_f32 v132, v88, v89
v_cvt_pk_bf16_f32 v133, v90, v91
v_cvt_pk_bf16_f32 v134, v92, v93
v_cvt_pk_bf16_f32 v135, v94, v95
ds_write_b128 v3, v[132:135] offset:3072
v_cvt_pk_bf16_f32 v136, v96, v97
v_cvt_pk_bf16_f32 v137, v98, v99
v_cvt_pk_bf16_f32 v138, v100, v101
v_cvt_pk_bf16_f32 v139, v102, v103
ds_write_b128 v3, v[136:139] offset:4096
s_waitcnt lgkmcnt(0)
s_barrier
ds_read_b128 v[64:67], v4 offset:0
ds_read_b128 v[68:71], v5 offset:0
ds_read_b128 v[72:75], v4 offset:10240
ds_read_b128 v[76:79], v5 offset:10240
ds_read_b128 v[80:83], v4 offset:20480
ds_read_b128 v[84:87], v5 offset:20480
ds_read_b128 v[88:91], v4 offset:30720
ds_read_b128 v[92:95], v5 offset:30720
ds_read_b128 v[96:99], v6 offset:0
ds_read_b128 v[100:103], v7 offset:0
ds_read_b128 v[104:107], v6 offset:10240
ds_read_b128 v[108:111], v7 offset:10240
ds_read_b128 v[112:115], v6 offset:20480
ds_read_b128 v[116:119], v7 offset:20480
ds_read_b128 v[120:123], v6 offset:30720
ds_read_b128 v[124:127], v7 offset:30720
s_cmp_eq_u32 s28, 0
s_cbranch_scc0 Lhint_13
s_lshl_b32 s68, s30, 4
s_add_u32 s68, s68, s91
s_add_u32 s68, s68, 64
s_lshl_b32 s68, s68, 7
s_add_u32 s68, s68, 10166272
v_mov_b32 v240, 0
v_mov_b32 v241, s70
s_mov_b64 exec, 1
buffer_store_dword v241, v240, s[64:67], s68 offen sc1
s_mov_b64 exec, -1
Lhint_13:
s_waitcnt lgkmcnt(14)
v_mfma_f32_16x16x32_bf16 v[160:163], v[64:67], v[68:71], 0
s_waitcnt lgkmcnt(12)
v_mfma_f32_16x16x32_bf16 v[160:163], v[72:75], v[76:79], v[160:163]
s_waitcnt lgkmcnt(10)
v_mfma_f32_16x16x32_bf16 v[160:163], v[80:83], v[84:87], v[160:163]
s_waitcnt lgkmcnt(8)
v_mfma_f32_16x16x32_bf16 v[160:163], v[88:91], v[92:95], v[160:163]
s_waitcnt lgkmcnt(6)
v_mfma_f32_16x16x32_bf16 v[164:167], v[96:99], v[100:103], 0
s_waitcnt lgkmcnt(4)
v_mfma_f32_16x16x32_bf16 v[164:167], v[104:107], v[108:111], v[164:167]
s_waitcnt lgkmcnt(2)
v_mfma_f32_16x16x32_bf16 v[164:167], v[112:115], v[116:119], v[164:167]
s_waitcnt lgkmcnt(0)
v_mfma_f32_16x16x32_bf16 v[164:167], v[120:123], v[124:127], v[164:167]
v_and_or_b32 v160, v160, v172, v168
v_and_or_b32 v161, v161, v172, v169
v_and_or_b32 v162, v162, v172, v170
v_and_or_b32 v163, v163, v172, v171
buffer_store_dwordx4 v[160:163], v2, s[64:67], s50 offen sc1
s_nop 2
v_and_or_b32 v164, v164, v172, v168
v_and_or_b32 v165, v165, v172, v169
v_and_or_b32 v166, v166, v172, v170
v_and_or_b32 v167, v167, v172, v171
s_add_u32 s50, s50, 8192
buffer_store_dwordx4 v[164:167], v2, s[64:67], s50 offen sc1
s_cmp_eq_u32 s51, 0
s_cbranch_scc1 Lkvz_14
v_mov_b32_dpp v176, v164 quad_perm:[0,0,0,0] row_mask:0xf bank_mask:0xf
v_mov_b32_dpp v177, v164 quad_perm:[1,1,1,1] row_mask:0xf bank_mask:0xf
v_mov_b32_dpp v178, v164 quad_perm:[2,2,2,2] row_mask:0xf bank_mask:0xf
v_mov_b32_dpp v179, v164 quad_perm:[3,3,3,3] row_mask:0xf bank_mask:0xf
v_and_or_b32 v176, v176, v172, v168
v_and_or_b32 v177, v177, v172, v169
v_and_or_b32 v178, v178, v172, v170
v_and_or_b32 v179, v179, v172, v171
s_mov_b32 exec_lo, 0
s_mov_b32 exec_hi, 0x1111
buffer_store_dwordx4 v[176:179], v9, s[64:67], s62 offen sc1
s_mov_b64 exec, -1
Lkvz_14:
s_cmp_eq_u32 s95, 1
s_cbranch_scc1 Learly_7
s_waitcnt vmcnt(2)
v_cmp_ne_u32 vcc, s70, v243
s_nop 0
s_cmp_eq_u64 vcc, 0
s_cbranch_scc1 Lf2_15
v_and_b32 v242, 31, v0
s_bfe_u32 s68, s93, 0x10004
s_lshl_b32 s68, s68, 5
s_add_u32 s68, s68, 0
v_add_u32 v242, s68, v242
v_lshlrev_b32 v242, 7, v242
v_add_u32 v242, 10166272, v242
s_mov_b32 s69, 0
Lwp_17:
buffer_load_dword v243, v242, s[64:67], 0 offen sc1
s_add_u32 s69, s69, 1
s_waitcnt vmcnt(0)
v_cmp_ne_u32 vcc, s70, v243
s_cmp_ge_u32 s69, 100000
s_cbranch_scc1 Lwf_16
s_cmp_lg_u64 vcc, 0
s_cbranch_scc1 Lwp_17
Lwf_16:
Lf2_15:
v_lshlrev_b32 v41, 4, v0
s_lshl_b32 s41, s88, 12
s_lshl_b32 s42, s89, 11
s_add_u32 s41, s41, s42
s_add_u32 s41, s41, 0
s_add_u32 s42, s42, s94
s_add_u32 m0, s42, 480
s_add_u32 s43, s41, 0
buffer_load_dwordx4 v41, s[64:67], s43 offen sc1 lds
s_add_u32 m0, s42, 1504
s_add_u32 s43, s41, 1024
buffer_load_dwordx4 v41, s[64:67], s43 offen sc1 lds
v_mov_b32 v44, 0
v_mov_b32 v45, 0
v_mov_b32 v46, 0
v_mov_b32 v47, 0
v_lshlrev_b32 v41, 4, v0
s_mov_b64 s[52:53], exec
s_cmp_eq_u32 s89, 0
s_cbranch_scc0 Lcz_19
v_lshrrev_b32 v42, 2, v0
v_mul_u32_u24 v42, 4160, v42
v_and_b32 v43, 3, v0
v_lshl_add_u32 v42, v43, 4, v42
v_add_u32 v42, s90, v42
s_mov_b64 exec, 0xffff
ds_write_b128 v42, v[44:47]
s_branch Lce_20
Lcz_19:
v_add_u32 v42, s94, v41
s_mov_b64 exec, 0x3fffffff
ds_write_b128 v42, v[44:47]
Lce_20:
s_mov_b64 exec, s[52:53]
s_lshl_b32 s41, s89, 11
s_add_u32 s41, s41, s90
v_add_u32 v42, s41, v41
ds_write_b128 v42, v[28:31] offset:64
v_mov_b32 v48, v25
v_mov_b32 v49, v28
v_mov_b32 v50, v29
v_mov_b32 v51, v30
ds_write_b128 v42, v[48:51] offset:8384
v_alignbit_b32 v52, v25, v24, 16
v_alignbit_b32 v53, v28, v25, 16
v_alignbit_b32 v54, v29, v28, 16
v_alignbit_b32 v55, v30, v29, 16
ds_write_b128 v42, v[52:55] offset:12544
v_mov_b32 v56, v53
v_mov_b32 v57, v54
v_mov_b32 v58, v55
v_alignbit_b32 v59, v31, v30, 16
ds_write_b128 v42, v[56:59] offset:4224
ds_write_b128 v42, v[36:39] offset:1088
v_mov_b32 v48, v33
v_mov_b32 v49, v36
v_mov_b32 v50, v37
v_mov_b32 v51, v38
ds_write_b128 v42, v[48:51] offset:9408
v_alignbit_b32 v52, v33, v32, 16
v_alignbit_b32 v53, v36, v33, 16
v_alignbit_b32 v54, v37, v36, 16
v_alignbit_b32 v55, v38, v37, 16
ds_write_b128 v42, v[52:55] offset:13568
v_mov_b32 v56, v53
v_mov_b32 v57, v54
v_mov_b32 v58, v55
v_alignbit_b32 v59, v39, v38, 16
ds_write_b128 v42, v[56:59] offset:5248
v_lshrrev_b32 v60, 4, v0
v_bfe_u32 v61, v0, 2, 2
v_and_b32 v62, 3, v0
v_mul_u32_u24 v10, 4160, v61
v_lshl_add_u32 v10, v62, 3, v10
v_lshlrev_b32 v11, 4, v60
v_sub_u32 v10, v10, v11
s_lshl_b32 s41, s89, 8
s_add_u32 s41, s41, s90
s_add_u32 s41, s41, 88
v_add_u32 v10, s41, v10
v_and_b32 v11, 15, v0
v_lshlrev_b32 v11, 5, v11
v_lshl_add_u32 v11, v60, 4, v11
s_lshl_b32 s41, s89, 8
s_sub_u32 s41, s94, s41
v_add_u32 v11, s41, v11
s_waitcnt vmcnt(0) lgkmcnt(0)
s_branch Ljoin_9
Learly_7:
s_waitcnt vmcnt(4)
v_mov_b32 v44, 0
v_mov_b32 v45, 0
v_mov_b32 v46, 0
v_mov_b32 v47, 0
v_lshlrev_b32 v41, 4, v0
s_mov_b64 s[52:53], exec
s_cmp_eq_u32 s89, 0
s_cbranch_scc0 Lcz_21
v_lshrrev_b32 v42, 2, v0
v_mul_u32_u24 v42, 4160, v42
v_and_b32 v43, 3, v0
v_lshl_add_u32 v42, v43, 4, v42
v_add_u32 v42, s90, v42
s_mov_b64 exec, 0xffff
ds_write_b128 v42, v[44:47]
s_branch Lce_22
Lcz_21:
v_add_u32 v42, s94, v41
s_mov_b64 exec, 0x3fffffff
ds_write_b128 v42, v[44:47]
Lce_22:
s_mov_b64 exec, s[52:53]
s_lshl_b32 s41, s89, 11
s_add_u32 s41, s41, s90
v_add_u32 v42, s41, v41
ds_write_b128 v42, v[28:31] offset:64
v_mov_b32 v48, v25
v_mov_b32 v49, v28
v_mov_b32 v50, v29
v_mov_b32 v51, v30
ds_write_b128 v42, v[48:51] offset:8384
v_alignbit_b32 v52, v25, v24, 16
v_alignbit_b32 v53, v28, v25, 16
v_alignbit_b32 v54, v29, v28, 16
v_alignbit_b32 v55, v30, v29, 16
ds_write_b128 v42, v[52:55] offset:12544
v_mov_b32 v56, v53
v_mov_b32 v57, v54
v_mov_b32 v58, v55
v_alignbit_b32 v59, v31, v30, 16
ds_write_b128 v42, v[56:59] offset:4224
ds_write_b128 v42, v[36:39] offset:1088
v_mov_b32 v48, v33
v_mov_b32 v49, v36
v_mov_b32 v50, v37
v_mov_b32 v51, v38
ds_write_b128 v42, v[48:51] offset:9408
v_alignbit_b32 v52, v33, v32, 16
v_alignbit_b32 v53, v36, v33, 16
v_alignbit_b32 v54, v37, v36, 16
v_alignbit_b32 v55, v38, v37, 16
ds_write_b128 v42, v[52:55] offset:13568
v_mov_b32 v56, v53
v_mov_b32 v57, v54
v_mov_b32 v58, v55
v_alignbit_b32 v59, v39, v38, 16
ds_write_b128 v42, v[56:59] offset:5248
v_lshrrev_b32 v60, 4, v0
v_bfe_u32 v61, v0, 2, 2
v_and_b32 v62, 3, v0
v_mul_u32_u24 v10, 4160, v61
v_lshl_add_u32 v10, v62, 3, v10
v_lshlrev_b32 v11, 4, v60
v_sub_u32 v10, v10, v11
s_lshl_b32 s41, s89, 8
s_add_u32 s41, s41, s90
s_add_u32 s41, s41, 88
v_add_u32 v10, s41, v10
v_and_b32 v11, 15, v0
v_lshlrev_b32 v11, 5, v11
v_lshl_add_u32 v11, v60, 4, v11
s_lshl_b32 s41, s89, 8
s_sub_u32 s41, s94, s41
v_add_u32 v11, s41, v11
s_waitcnt vmcnt(2) lgkmcnt(0)
Ljoin_9:
s_barrier
s_branch concat_heads__linear_attn_block__ssm_conv_h3__prompt_kernel_convmain
concat_heads__linear_attn_block__ssm_conv_h3__prompt_kernel_kvnoconv:
s_cmp_eq_u32 s48, 0
s_cbranch_scc0 Lkvb_23
v_pk_mul_f32 v[104:105], v[64:65], s[56:57]
v_pk_mul_f32 v[106:107], v[66:67], s[56:57]
v_pk_mul_f32 v[108:109], v[68:69], s[56:57]
v_pk_mul_f32 v[110:111], v[70:71], s[56:57]
v_exp_f32 v104, v104 clamp
v_exp_f32 v105, v105 clamp
v_exp_f32 v106, v106 clamp
v_exp_f32 v107, v107 clamp
v_exp_f32 v108, v108 clamp
v_exp_f32 v109, v109 clamp
v_exp_f32 v110, v110 clamp
v_exp_f32 v111, v111 clamp
v_max_f32 v64, 0, v64
v_max_f32 v65, 0, v65
v_max_f32 v66, 0, v66
v_max_f32 v67, 0, v67
v_max_f32 v68, 0, v68
v_max_f32 v69, 0, v69
v_max_f32 v70, 0, v70
v_max_f32 v71, 0, v71
v_pk_add_f32 v[104:105], v[104:105], s[58:59]
v_pk_add_f32 v[106:107], v[106:107], s[58:59]
v_pk_add_f32 v[108:109], v[108:109], s[58:59]
v_pk_add_f32 v[110:111], v[110:111], s[58:59]
v_pk_add_f32 v[64:65], v[64:65], v[104:105]
v_pk_add_f32 v[66:67], v[66:67], v[106:107]
v_pk_add_f32 v[68:69], v[68:69], v[108:109]
v_pk_add_f32 v[70:71], v[70:71], v[110:111]
v_pk_mul_f32 v[104:105], v[72:73], s[56:57]
v_pk_mul_f32 v[106:107], v[74:75], s[56:57]
v_pk_mul_f32 v[108:109], v[76:77], s[56:57]
v_pk_mul_f32 v[110:111], v[78:79], s[56:57]
v_exp_f32 v104, v104 clamp
v_exp_f32 v105, v105 clamp
v_exp_f32 v106, v106 clamp
v_exp_f32 v107, v107 clamp
v_exp_f32 v108, v108 clamp
v_exp_f32 v109, v109 clamp
v_exp_f32 v110, v110 clamp
v_exp_f32 v111, v111 clamp
v_max_f32 v72, 0, v72
v_max_f32 v73, 0, v73
v_max_f32 v74, 0, v74
v_max_f32 v75, 0, v75
v_max_f32 v76, 0, v76
v_max_f32 v77, 0, v77
v_max_f32 v78, 0, v78
v_max_f32 v79, 0, v79
v_pk_add_f32 v[104:105], v[104:105], s[58:59]
v_pk_add_f32 v[106:107], v[106:107], s[58:59]
v_pk_add_f32 v[108:109], v[108:109], s[58:59]
v_pk_add_f32 v[110:111], v[110:111], s[58:59]
v_pk_add_f32 v[72:73], v[72:73], v[104:105]
v_pk_add_f32 v[74:75], v[74:75], v[106:107]
v_pk_add_f32 v[76:77], v[76:77], v[108:109]
v_pk_add_f32 v[78:79], v[78:79], v[110:111]
v_pk_mul_f32 v[104:105], v[80:81], s[56:57]
v_pk_mul_f32 v[106:107], v[82:83], s[56:57]
v_pk_mul_f32 v[108:109], v[84:85], s[56:57]
v_pk_mul_f32 v[110:111], v[86:87], s[56:57]
v_exp_f32 v104, v104 clamp
v_exp_f32 v105, v105 clamp
v_exp_f32 v106, v106 clamp
v_exp_f32 v107, v107 clamp
v_exp_f32 v108, v108 clamp
v_exp_f32 v109, v109 clamp
v_exp_f32 v110, v110 clamp
v_exp_f32 v111, v111 clamp
v_max_f32 v80, 0, v80
v_max_f32 v81, 0, v81
v_max_f32 v82, 0, v82
v_max_f32 v83, 0, v83
v_max_f32 v84, 0, v84
v_max_f32 v85, 0, v85
v_max_f32 v86, 0, v86
v_max_f32 v87, 0, v87
v_pk_add_f32 v[104:105], v[104:105], s[58:59]
v_pk_add_f32 v[106:107], v[106:107], s[58:59]
v_pk_add_f32 v[108:109], v[108:109], s[58:59]
v_pk_add_f32 v[110:111], v[110:111], s[58:59]
v_pk_add_f32 v[80:81], v[80:81], v[104:105]
v_pk_add_f32 v[82:83], v[82:83], v[106:107]
v_pk_add_f32 v[84:85], v[84:85], v[108:109]
v_pk_add_f32 v[86:87], v[86:87], v[110:111]
s_branch Lkvc_24
Lkvb_23:
v_pk_mul_f32 v[104:105], v[88:89], s[56:57]
v_pk_mul_f32 v[106:107], v[90:91], s[56:57]
v_pk_mul_f32 v[108:109], v[92:93], s[56:57]
v_pk_mul_f32 v[110:111], v[94:95], s[56:57]
v_exp_f32 v104, v104 clamp
v_exp_f32 v105, v105 clamp
v_exp_f32 v106, v106 clamp
v_exp_f32 v107, v107 clamp
v_exp_f32 v108, v108 clamp
v_exp_f32 v109, v109 clamp
v_exp_f32 v110, v110 clamp
v_exp_f32 v111, v111 clamp
v_max_f32 v88, 0, v88
v_max_f32 v89, 0, v89
v_max_f32 v90, 0, v90
v_max_f32 v91, 0, v91
v_max_f32 v92, 0, v92
v_max_f32 v93, 0, v93
v_max_f32 v94, 0, v94
v_max_f32 v95, 0, v95
v_pk_add_f32 v[104:105], v[104:105], s[58:59]
v_pk_add_f32 v[106:107], v[106:107], s[58:59]
v_pk_add_f32 v[108:109], v[108:109], s[58:59]
v_pk_add_f32 v[110:111], v[110:111], s[58:59]
v_pk_add_f32 v[88:89], v[88:89], v[104:105]
v_pk_add_f32 v[90:91], v[90:91], v[106:107]
v_pk_add_f32 v[92:93], v[92:93], v[108:109]
v_pk_add_f32 v[94:95], v[94:95], v[110:111]
v_pk_mul_f32 v[104:105], v[96:97], s[56:57]
v_pk_mul_f32 v[106:107], v[98:99], s[56:57]
v_pk_mul_f32 v[108:109], v[100:101], s[56:57]
v_pk_mul_f32 v[110:111], v[102:103], s[56:57]
v_exp_f32 v104, v104 clamp
v_exp_f32 v105, v105 clamp
v_exp_f32 v106, v106 clamp
v_exp_f32 v107, v107 clamp
v_exp_f32 v108, v108 clamp
v_exp_f32 v109, v109 clamp
v_exp_f32 v110, v110 clamp
v_exp_f32 v111, v111 clamp
v_max_f32 v96, 0, v96
v_max_f32 v97, 0, v97
v_max_f32 v98, 0, v98
v_max_f32 v99, 0, v99
v_max_f32 v100, 0, v100
v_max_f32 v101, 0, v101
v_max_f32 v102, 0, v102
v_max_f32 v103, 0, v103
v_pk_add_f32 v[104:105], v[104:105], s[58:59]
v_pk_add_f32 v[106:107], v[106:107], s[58:59]
v_pk_add_f32 v[108:109], v[108:109], s[58:59]
v_pk_add_f32 v[110:111], v[110:111], s[58:59]
v_pk_add_f32 v[96:97], v[96:97], v[104:105]
v_pk_add_f32 v[98:99], v[98:99], v[106:107]
v_pk_add_f32 v[100:101], v[100:101], v[108:109]
v_pk_add_f32 v[102:103], v[102:103], v[110:111]
Lkvc_24:
v_cvt_pk_bf16_f32 v120, v64, v65
v_cvt_pk_bf16_f32 v121, v66, v67
v_cvt_pk_bf16_f32 v122, v68, v69
v_cvt_pk_bf16_f32 v123, v70, v71
ds_write_b128 v3, v[120:123] offset:0
v_cvt_pk_bf16_f32 v124, v72, v73
v_cvt_pk_bf16_f32 v125, v74, v75
v_cvt_pk_bf16_f32 v126, v76, v77
v_cvt_pk_bf16_f32 v127, v78, v79
ds_write_b128 v3, v[124:127] offset:1024
v_cvt_pk_bf16_f32 v128, v80, v81
v_cvt_pk_bf16_f32 v129, v82, v83
v_cvt_pk_bf16_f32 v130, v84, v85
v_cvt_pk_bf16_f32 v131, v86, v87
v_cndmask_b32 v128, v128, v8, s[60:61]
v_cndmask_b32 v129, v129, v8, s[60:61]
v_cndmask_b32 v130, v130, v8, s[60:61]
v_cndmask_b32 v131, v131, v8, s[60:61]
ds_write_b128 v3, v[128:131] offset:2048
v_cvt_pk_bf16_f32 v132, v88, v89
v_cvt_pk_bf16_f32 v133, v90, v91
v_cvt_pk_bf16_f32 v134, v92, v93
v_cvt_pk_bf16_f32 v135, v94, v95
ds_write_b128 v3, v[132:135] offset:3072
v_cvt_pk_bf16_f32 v136, v96, v97
v_cvt_pk_bf16_f32 v137, v98, v99
v_cvt_pk_bf16_f32 v138, v100, v101
v_cvt_pk_bf16_f32 v139, v102, v103
ds_write_b128 v3, v[136:139] offset:4096
s_waitcnt lgkmcnt(0)
s_barrier
ds_read_b128 v[64:67], v4 offset:0
ds_read_b128 v[68:71], v5 offset:0
ds_read_b128 v[72:75], v4 offset:10240
ds_read_b128 v[76:79], v5 offset:10240
ds_read_b128 v[80:83], v4 offset:20480
ds_read_b128 v[84:87], v5 offset:20480
ds_read_b128 v[88:91], v4 offset:30720
ds_read_b128 v[92:95], v5 offset:30720
ds_read_b128 v[96:99], v6 offset:0
ds_read_b128 v[100:103], v7 offset:0
ds_read_b128 v[104:107], v6 offset:10240
ds_read_b128 v[108:111], v7 offset:10240
ds_read_b128 v[112:115], v6 offset:20480
ds_read_b128 v[116:119], v7 offset:20480
ds_read_b128 v[120:123], v6 offset:30720
ds_read_b128 v[124:127], v7 offset:30720
s_cmp_eq_u32 s28, 0
s_cbranch_scc0 Lhint_25
s_lshl_b32 s68, s30, 4
s_add_u32 s68, s68, s91
s_add_u32 s68, s68, 64
s_lshl_b32 s68, s68, 7
s_add_u32 s68, s68, 10166272
v_mov_b32 v240, 0
v_mov_b32 v241, s70
s_mov_b64 exec, 1
buffer_store_dword v241, v240, s[64:67], s68 offen sc1
s_mov_b64 exec, -1
Lhint_25:
s_waitcnt lgkmcnt(14)
v_mfma_f32_16x16x32_bf16 v[160:163], v[64:67], v[68:71], 0
s_waitcnt lgkmcnt(12)
v_mfma_f32_16x16x32_bf16 v[160:163], v[72:75], v[76:79], v[160:163]
s_waitcnt lgkmcnt(10)
v_mfma_f32_16x16x32_bf16 v[160:163], v[80:83], v[84:87], v[160:163]
s_waitcnt lgkmcnt(8)
v_mfma_f32_16x16x32_bf16 v[160:163], v[88:91], v[92:95], v[160:163]
s_waitcnt lgkmcnt(6)
v_mfma_f32_16x16x32_bf16 v[164:167], v[96:99], v[100:103], 0
s_waitcnt lgkmcnt(4)
v_mfma_f32_16x16x32_bf16 v[164:167], v[104:107], v[108:111], v[164:167]
s_waitcnt lgkmcnt(2)
v_mfma_f32_16x16x32_bf16 v[164:167], v[112:115], v[116:119], v[164:167]
s_waitcnt lgkmcnt(0)
v_mfma_f32_16x16x32_bf16 v[164:167], v[120:123], v[124:127], v[164:167]
v_and_or_b32 v160, v160, v172, v168
v_and_or_b32 v161, v161, v172, v169
v_and_or_b32 v162, v162, v172, v170
v_and_or_b32 v163, v163, v172, v171
buffer_store_dwordx4 v[160:163], v2, s[64:67], s50 offen sc1
s_nop 2
v_and_or_b32 v164, v164, v172, v168
v_and_or_b32 v165, v165, v172, v169
v_and_or_b32 v166, v166, v172, v170
v_and_or_b32 v167, v167, v172, v171
s_add_u32 s50, s50, 8192
buffer_store_dwordx4 v[164:167], v2, s[64:67], s50 offen sc1
s_cmp_eq_u32 s51, 0
s_cbranch_scc1 Lkvz_26
v_mov_b32_dpp v176, v164 quad_perm:[0,0,0,0] row_mask:0xf bank_mask:0xf
v_mov_b32_dpp v177, v164 quad_perm:[1,1,1,1] row_mask:0xf bank_mask:0xf
v_mov_b32_dpp v178, v164 quad_perm:[2,2,2,2] row_mask:0xf bank_mask:0xf
v_mov_b32_dpp v179, v164 quad_perm:[3,3,3,3] row_mask:0xf bank_mask:0xf
v_and_or_b32 v176, v176, v172, v168
v_and_or_b32 v177, v177, v172, v169
v_and_or_b32 v178, v178, v172, v170
v_and_or_b32 v179, v179, v172, v171
s_mov_b32 exec_lo, 0
s_mov_b32 exec_hi, 0x1111
buffer_store_dwordx4 v[176:179], v9, s[64:67], s62 offen sc1
s_mov_b64 exec, -1
Lkvz_26:
s_barrier
concat_heads__linear_attn_block__ssm_conv_h3__prompt_kernel_kvnext:
s_cmp_ge_u32 s73, 64
s_cbranch_scc1 concat_heads__linear_attn_block__ssm_conv_h3__prompt_kernel_b3
s_mov_b32 s59, s72
s_branch concat_heads__linear_attn_block__ssm_conv_h3__prompt_kernel_out
concat_heads__linear_attn_block__ssm_conv_h3__prompt_kernel_q:
s_and_b32 s41, s71, 3
s_lshl_b32 s41, s41, 2
s_and_b32 s29, s72, 3
s_add_u32 s29, s29, s41
s_lshr_b32 s41, s71, 2
s_lshl_b32 s41, s41, 1
s_bfe_u32 s30, s72, 0x10002
s_add_u32 s30, s30, s41
s_and_b32 s41, s29, 3
s_lshl_b32 s41, s41, 1
s_and_b32 s42, s30, 1
s_lshl_b32 s42, s42, 2
s_add_u32 s41, s41, s42
s_add_u32 s41, s41, 1
s_cmp_ge_u32 s41, 9
s_cselect_b32 s42, 9, 0
s_sub_u32 s41, s41, s42
s_lshl_b32 s46, s41, 7
s_mov_b32 s76, s46
s_add_u32 s46, s46, 128
s_cmp_eq_u32 s46, 1152
s_cselect_b32 s46, 0, s46
s_mov_b32 s77, s46
s_add_u32 s46, s46, 128
s_cmp_eq_u32 s46, 1152
s_cselect_b32 s46, 0, s46
s_mov_b32 s78, s46
s_add_u32 s46, s46, 128
s_cmp_eq_u32 s46, 1152
s_cselect_b32 s46, 0, s46
s_mov_b32 s79, s46
s_add_u32 s46, s46, 128
s_cmp_eq_u32 s46, 1152
s_cselect_b32 s46, 0, s46
s_mov_b32 s80, s46
s_add_u32 s46, s46, 128
s_cmp_eq_u32 s46, 1152
s_cselect_b32 s46, 0, s46
s_mov_b32 s81, s46
s_add_u32 s46, s46, 128
s_cmp_eq_u32 s46, 1152
s_cselect_b32 s46, 0, s46
s_mov_b32 s82, s46
s_add_u32 s46, s46, 128
s_cmp_eq_u32 s46, 1152
s_cselect_b32 s46, 0, s46
s_mov_b32 s83, s46
s_add_u32 s46, s46, 128
s_cmp_eq_u32 s46, 1152
s_cselect_b32 s46, 0, s46
s_mov_b32 s84, s46
v_lshrrev_b32 v2, 3, v0
v_and_b32 v3, 7, v0
v_xor_b32 v3, v3, v2
s_lshl_b32 s41, s29, 7
s_lshl_b32 s42, s28, 4
s_add_u32 s41, s41, s42
v_lshlrev_b32 v3, 4, v3
v_add_u32 v2, s41, v2
v_mul_u32_u24 v2, 1152, v2
v_add_u32 v16, v2, v3
s_mul_i32 s42, s30, 288
s_lshl_b32 s41, s28, 6
s_lshl_b32 s43, s28, 7
v_add_u32 v2, s43, v0
v_mul_u32_u24 v3, 27595, v2
v_lshrrev_b32 v3, 22, v3
v_mul_u32_u24 v4, 152, v3
v_sub_u32 v4, v2, v4
v_min_u32 v4, 143, v4
v_mul_u32_u24 v5, 3641, v4
v_lshrrev_b32 v5, 16, v5
v_mul_u32_u24 v6, 18, v5
v_sub_u32 v6, v4, v6
v_lshl_add_u32 v5, v3, 3, v5
v_mul_u32_u24 v5, 3456, v5
v_lshl_add_u32 v5, v6, 4, v5
v_add_u32 v17, s42, v5
v_add_u32 v2, s43, v0
v_add_u32 v2, 64, v2
v_mul_u32_u24 v3, 27595, v2
v_lshrrev_b32 v3, 22, v3
v_mul_u32_u24 v4, 152, v3
v_sub_u32 v4, v2, v4
v_min_u32 v4, 143, v4
v_mul_u32_u24 v5, 3641, v4
v_lshrrev_b32 v5, 16, v5
v_mul_u32_u24 v6, 18, v5
v_sub_u32 v6, v4, v6
v_lshl_add_u32 v5, v3, 3, v5
v_mul_u32_u24 v5, 3456, v5
v_lshl_add_u32 v5, v6, 4, v5
v_add_u32 v18, s42, v5
v_add_u32 v2, s41, v0
v_add_u32 v2, 1024, v2
v_mul_u32_u24 v3, 27595, v2
v_lshrrev_b32 v3, 22, v3
v_mul_u32_u24 v4, 152, v3
v_sub_u32 v4, v2, v4
v_min_u32 v4, 143, v4
v_mul_u32_u24 v5, 3641, v4
v_lshrrev_b32 v5, 16, v5
v_mul_u32_u24 v6, 18, v5
v_sub_u32 v6, v4, v6
v_lshl_add_u32 v5, v3, 3, v5
v_mul_u32_u24 v5, 3456, v5
v_lshl_add_u32 v5, v6, 4, v5
v_add_u32 v19, s42, v5
s_cmp_lt_u32 s28, 3
s_cselect_b32 s43, -1, 0
v_and_b32 v19, s43, v19
v_subrev_u32 v18, 1024, v18
v_add_u32 v22, 8192, v16
s_lshl_b32 s41, s28, 10
s_lshl_b32 s45, s28, 11
s_add_u32 s45, s45, 16384
s_add_u32 s41, s41, 32768
s_cmp_lt_u32 s28, 3
s_cselect_b32 s40, s41, 35840
s_lshl_b32 s44, s28, 11
s_and_b32 s41, s28, 3
s_lshl_b32 s41, s41, 12
v_and_b32 v2, 15, v0
v_lshrrev_b32 v3, 4, v0
v_and_b32 v4, 7, v2
v_xor_b32 v4, v4, v3
v_lshlrev_b32 v4, 4, v4
v_lshl_add_u32 v4, v2, 7, v4
v_add_u32 v10, s41, v4
v_xor_b32 v11, 64, v10
v_mul_u32_u24 v4, 2432, v3
v_bfe_u32 v5, v0, 2, 2
v_mul_u32_u24 v5, 288, v5
v_and_b32 v6, 3, v0
v_lshlrev_b32 v6, 3, v6
v_add3_u32 v4, v4, v5, v6
s_lshr_b32 s41, s28, 2
s_mul_i32 s41, s41, 144
s_add_u32 s41, s41, 16384
v_add_u32 v12, s41, v4
v_add_u32 v20, 96, v12
v_add_u32 v44, 0, v10
v_add_u32 v45, 0, v11
v_add_u32 v46, 0, v12
v_add_u32 v47, 0, v20
v_add_u32 v48, 36864, v10
v_add_u32 v49, 36864, v11
v_add_u32 v50, 36864, v12
v_add_u32 v51, 36864, v20
v_add_u32 v52, 73728, v10
v_add_u32 v53, 73728, v11
v_add_u32 v54, 73728, v12
v_add_u32 v55, 73728, v20
v_add_u32 v56, 110592, v10
v_add_u32 v57, 110592, v11
v_add_u32 v58, 110592, v12
v_add_u32 v59, 110592, v20
s_waitcnt lgkmcnt(0)
s_mov_b32 s64, s26
s_mov_b32 s65, s27
s_mov_b32 s66, 0x9d2000
s_mov_b32 s67, 0x20000
s_mov_b32 s32, s4
s_mov_b32 s33, s5
s_mov_b32 s34, 0x240000
s_mov_b32 s35, 0x20000
s_mov_b32 s36, s6
s_mov_b32 s37, s7
s_mov_b32 s38, 0x1e6000
s_mov_b32 s39, 0x20000
s_add_u32 m0, s44, 0
s_mul_i32 s47, s76, 1728
buffer_load_dwordx4 v16, s[32:35], s76 offen  lds
buffer_load_dwordx4 v22, s[32:35], s76 offen offset:1024  lds
s_add_u32 m0, s45, 0
s_nop 0
buffer_load_dwordx4 v17, s[36:39], s47 offen  lds
buffer_load_dwordx4 v18, s[36:39], s47 offen offset:1024  lds
s_add_u32 m0, s40, 0
s_nop 0
buffer_load_dwordx4 v19, s[36:39], s47 offen  lds
s_barrier
s_add_u32 m0, s44, 36864
s_mul_i32 s47, s77, 1728
buffer_load_dwordx4 v16, s[32:35], s77 offen  lds
buffer_load_dwordx4 v22, s[32:35], s77 offen offset:1024  lds
s_add_u32 m0, s45, 36864
s_nop 0
buffer_load_dwordx4 v17, s[36:39], s47 offen  lds
buffer_load_dwordx4 v18, s[36:39], s47 offen offset:1024  lds
s_add_u32 m0, s40, 36864
s_nop 0
buffer_load_dwordx4 v19, s[36:39], s47 offen  lds
s_waitcnt vmcnt(5)
s_barrier
ds_read_b128 v[104:107], v44 offset:0
ds_read_b128 v[108:111], v44 offset:2048
ds_read_b64_tr_b16 v[120:121], v46 offset:0
ds_read_b64_tr_b16 v[122:123], v46 offset:1152
ds_read_b64_tr_b16 v[124:125], v46 offset:32
ds_read_b64_tr_b16 v[126:127], v46 offset:1184
ds_read_b64_tr_b16 v[128:129], v46 offset:64
ds_read_b64_tr_b16 v[130:131], v46 offset:1216
ds_read_b64_tr_b16 v[132:133], v47 offset:0
ds_read_b64_tr_b16 v[134:135], v47 offset:1152
ds_read_b64_tr_b16 v[136:137], v47 offset:32
ds_read_b64_tr_b16 v[138:139], v47 offset:1184
s_waitcnt lgkmcnt(6)
v_mfma_f32_16x16x32_bf16 v[64:67], v[120:123], v[104:107], 0
ds_read_b128 v[112:115], v45 offset:0
ds_read_b128 v[116:119], v45 offset:2048
v_mfma_f32_16x16x32_bf16 v[68:71], v[120:123], v[108:111], 0
ds_read_b64_tr_b16 v[140:141], v46 offset:9728
s_add_u32 m0, s44, 73728
s_mul_i32 s47, s78, 1728
buffer_load_dwordx4 v16, s[32:35], s78 offen  lds
buffer_load_dwordx4 v22, s[32:35], s78 offen offset:1024  lds
s_add_u32 m0, s45, 73728
s_nop 0
buffer_load_dwordx4 v17, s[36:39], s47 offen  lds
buffer_load_dwordx4 v18, s[36:39], s47 offen offset:1024  lds
s_add_u32 m0, s40, 73728
s_nop 0
buffer_load_dwordx4 v19, s[36:39], s47 offen  lds
v_mfma_f32_16x16x32_bf16 v[72:75], v[124:127], v[104:107], 0
ds_read_b64_tr_b16 v[142:143], v46 offset:10880
ds_read_b64_tr_b16 v[144:145], v46 offset:9760
v_mfma_f32_16x16x32_bf16 v[76:79], v[124:127], v[108:111], 0
ds_read_b64_tr_b16 v[146:147], v46 offset:10912
s_waitcnt lgkmcnt(8)
v_mfma_f32_16x16x32_bf16 v[80:83], v[128:131], v[104:107], 0
ds_read_b64_tr_b16 v[148:149], v46 offset:9792
ds_read_b64_tr_b16 v[150:151], v46 offset:10944
v_mfma_f32_16x16x32_bf16 v[84:87], v[128:131], v[108:111], 0
ds_read_b64_tr_b16 v[152:153], v47 offset:9728
v_mfma_f32_16x16x32_bf16 v[88:91], v[132:135], v[104:107], 0
ds_read_b64_tr_b16 v[154:155], v47 offset:10880
ds_read_b64_tr_b16 v[156:157], v47 offset:9760
v_mfma_f32_16x16x32_bf16 v[92:95], v[132:135], v[108:111], 0
ds_read_b64_tr_b16 v[158:159], v47 offset:10912
s_waitcnt lgkmcnt(12)
v_mfma_f32_16x16x32_bf16 v[96:99], v[136:139], v[104:107], 0
v_mfma_f32_16x16x32_bf16 v[100:103], v[136:139], v[108:111], 0
s_waitcnt vmcnt(5)
s_barrier
s_waitcnt lgkmcnt(6)
v_mfma_f32_16x16x32_bf16 v[64:67], v[140:143], v[112:115], v[64:67]
ds_read_b128 v[104:107], v48 offset:0
ds_read_b128 v[108:111], v48 offset:2048
v_mfma_f32_16x16x32_bf16 v[68:71], v[140:143], v[116:119], v[68:71]
ds_read_b64_tr_b16 v[120:121], v50 offset:0
s_add_u32 m0, s44, 110592
s_mul_i32 s47, s79, 1728
buffer_load_dwordx4 v16, s[32:35], s79 offen  lds
buffer_load_dwordx4 v22, s[32:35], s79 offen offset:1024  lds
s_add_u32 m0, s45, 110592
s_nop 0
buffer_load_dwordx4 v17, s[36:39], s47 offen  lds
buffer_load_dwordx4 v18, s[36:39], s47 offen offset:1024  lds
s_add_u32 m0, s40, 110592
s_nop 0
buffer_load_dwordx4 v19, s[36:39], s47 offen  lds
v_mfma_f32_16x16x32_bf16 v[72:75], v[144:147], v[112:115], v[72:75]
ds_read_b64_tr_b16 v[122:123], v50 offset:1152
ds_read_b64_tr_b16 v[124:125], v50 offset:32
v_mfma_f32_16x16x32_bf16 v[76:79], v[144:147], v[116:119], v[76:79]
ds_read_b64_tr_b16 v[126:127], v50 offset:1184
s_waitcnt lgkmcnt(8)
v_mfma_f32_16x16x32_bf16 v[80:83], v[148:151], v[112:115], v[80:83]
ds_read_b64_tr_b16 v[128:129], v50 offset:64
ds_read_b64_tr_b16 v[130:131], v50 offset:1216
v_mfma_f32_16x16x32_bf16 v[84:87], v[148:151], v[116:119], v[84:87]
ds_read_b64_tr_b16 v[132:133], v51 offset:0
v_mfma_f32_16x16x32_bf16 v[88:91], v[152:155], v[112:115], v[88:91]
ds_read_b64_tr_b16 v[134:135], v51 offset:1152
ds_read_b64_tr_b16 v[136:137], v51 offset:32
v_mfma_f32_16x16x32_bf16 v[92:95], v[152:155], v[116:119], v[92:95]
ds_read_b64_tr_b16 v[138:139], v51 offset:1184
s_waitcnt lgkmcnt(12)
v_mfma_f32_16x16x32_bf16 v[96:99], v[156:159], v[112:115], v[96:99]
v_mfma_f32_16x16x32_bf16 v[100:103], v[156:159], v[116:119], v[100:103]
s_waitcnt lgkmcnt(6)
v_mfma_f32_16x16x32_bf16 v[64:67], v[120:123], v[104:107], v[64:67]
ds_read_b128 v[112:115], v49 offset:0
ds_read_b128 v[116:119], v49 offset:2048
v_mfma_f32_16x16x32_bf16 v[68:71], v[120:123], v[108:111], v[68:71]
ds_read_b64_tr_b16 v[140:141], v50 offset:9728
v_mfma_f32_16x16x32_bf16 v[72:75], v[124:127], v[104:107], v[72:75]
ds_read_b64_tr_b16 v[142:143], v50 offset:10880
ds_read_b64_tr_b16 v[144:145], v50 offset:9760
v_mfma_f32_16x16x32_bf16 v[76:79], v[124:127], v[108:111], v[76:79]
ds_read_b64_tr_b16 v[146:147], v50 offset:10912
s_waitcnt lgkmcnt(8)
v_mfma_f32_16x16x32_bf16 v[80:83], v[128:131], v[104:107], v[80:83]
ds_read_b64_tr_b16 v[148:149], v50 offset:9792
ds_read_b64_tr_b16 v[150:151], v50 offset:10944
v_mfma_f32_16x16x32_bf16 v[84:87], v[128:131], v[108:111], v[84:87]
ds_read_b64_tr_b16 v[152:153], v51 offset:9728
v_mfma_f32_16x16x32_bf16 v[88:91], v[132:135], v[104:107], v[88:91]
ds_read_b64_tr_b16 v[154:155], v51 offset:10880
ds_read_b64_tr_b16 v[156:157], v51 offset:9760
v_mfma_f32_16x16x32_bf16 v[92:95], v[132:135], v[108:111], v[92:95]
ds_read_b64_tr_b16 v[158:159], v51 offset:10912
s_waitcnt lgkmcnt(12)
v_mfma_f32_16x16x32_bf16 v[96:99], v[136:139], v[104:107], v[96:99]
v_mfma_f32_16x16x32_bf16 v[100:103], v[136:139], v[108:111], v[100:103]
s_waitcnt vmcnt(5)
s_barrier
s_waitcnt lgkmcnt(6)
v_mfma_f32_16x16x32_bf16 v[64:67], v[140:143], v[112:115], v[64:67]
ds_read_b128 v[104:107], v52 offset:0
ds_read_b128 v[108:111], v52 offset:2048
v_mfma_f32_16x16x32_bf16 v[68:71], v[140:143], v[116:119], v[68:71]
ds_read_b64_tr_b16 v[120:121], v54 offset:0
s_add_u32 m0, s44, 0
s_mul_i32 s47, s80, 1728
buffer_load_dwordx4 v16, s[32:35], s80 offen  lds
buffer_load_dwordx4 v22, s[32:35], s80 offen offset:1024  lds
s_add_u32 m0, s45, 0
s_nop 0
buffer_load_dwordx4 v17, s[36:39], s47 offen  lds
buffer_load_dwordx4 v18, s[36:39], s47 offen offset:1024  lds
s_add_u32 m0, s40, 0
s_nop 0
buffer_load_dwordx4 v19, s[36:39], s47 offen  lds
v_mfma_f32_16x16x32_bf16 v[72:75], v[144:147], v[112:115], v[72:75]
ds_read_b64_tr_b16 v[122:123], v54 offset:1152
ds_read_b64_tr_b16 v[124:125], v54 offset:32
v_mfma_f32_16x16x32_bf16 v[76:79], v[144:147], v[116:119], v[76:79]
ds_read_b64_tr_b16 v[126:127], v54 offset:1184
s_waitcnt lgkmcnt(8)
v_mfma_f32_16x16x32_bf16 v[80:83], v[148:151], v[112:115], v[80:83]
ds_read_b64_tr_b16 v[128:129], v54 offset:64
ds_read_b64_tr_b16 v[130:131], v54 offset:1216
v_mfma_f32_16x16x32_bf16 v[84:87], v[148:151], v[116:119], v[84:87]
ds_read_b64_tr_b16 v[132:133], v55 offset:0
v_mfma_f32_16x16x32_bf16 v[88:91], v[152:155], v[112:115], v[88:91]
ds_read_b64_tr_b16 v[134:135], v55 offset:1152
ds_read_b64_tr_b16 v[136:137], v55 offset:32
v_mfma_f32_16x16x32_bf16 v[92:95], v[152:155], v[116:119], v[92:95]
ds_read_b64_tr_b16 v[138:139], v55 offset:1184
s_waitcnt lgkmcnt(12)
v_mfma_f32_16x16x32_bf16 v[96:99], v[156:159], v[112:115], v[96:99]
v_mfma_f32_16x16x32_bf16 v[100:103], v[156:159], v[116:119], v[100:103]
s_waitcnt lgkmcnt(6)
v_mfma_f32_16x16x32_bf16 v[64:67], v[120:123], v[104:107], v[64:67]
ds_read_b128 v[112:115], v53 offset:0
ds_read_b128 v[116:119], v53 offset:2048
v_mfma_f32_16x16x32_bf16 v[68:71], v[120:123], v[108:111], v[68:71]
ds_read_b64_tr_b16 v[140:141], v54 offset:9728
v_mfma_f32_16x16x32_bf16 v[72:75], v[124:127], v[104:107], v[72:75]
ds_read_b64_tr_b16 v[142:143], v54 offset:10880
ds_read_b64_tr_b16 v[144:145], v54 offset:9760
v_mfma_f32_16x16x32_bf16 v[76:79], v[124:127], v[108:111], v[76:79]
ds_read_b64_tr_b16 v[146:147], v54 offset:10912
s_waitcnt lgkmcnt(8)
v_mfma_f32_16x16x32_bf16 v[80:83], v[128:131], v[104:107], v[80:83]
ds_read_b64_tr_b16 v[148:149], v54 offset:9792
ds_read_b64_tr_b16 v[150:151], v54 offset:10944
v_mfma_f32_16x16x32_bf16 v[84:87], v[128:131], v[108:111], v[84:87]
ds_read_b64_tr_b16 v[152:153], v55 offset:9728
v_mfma_f32_16x16x32_bf16 v[88:91], v[132:135], v[104:107], v[88:91]
ds_read_b64_tr_b16 v[154:155], v55 offset:10880
ds_read_b64_tr_b16 v[156:157], v55 offset:9760
v_mfma_f32_16x16x32_bf16 v[92:95], v[132:135], v[108:111], v[92:95]
ds_read_b64_tr_b16 v[158:159], v55 offset:10912
s_waitcnt lgkmcnt(12)
v_mfma_f32_16x16x32_bf16 v[96:99], v[136:139], v[104:107], v[96:99]
v_mfma_f32_16x16x32_bf16 v[100:103], v[136:139], v[108:111], v[100:103]
s_waitcnt vmcnt(5)
s_barrier
s_waitcnt lgkmcnt(6)
v_mfma_f32_16x16x32_bf16 v[64:67], v[140:143], v[112:115], v[64:67]
ds_read_b128 v[104:107], v56 offset:0
ds_read_b128 v[108:111], v56 offset:2048
v_mfma_f32_16x16x32_bf16 v[68:71], v[140:143], v[116:119], v[68:71]
ds_read_b64_tr_b16 v[120:121], v58 offset:0
s_add_u32 m0, s44, 36864
s_mul_i32 s47, s81, 1728
buffer_load_dwordx4 v16, s[32:35], s81 offen  lds
buffer_load_dwordx4 v22, s[32:35], s81 offen offset:1024  lds
s_add_u32 m0, s45, 36864
s_nop 0
buffer_load_dwordx4 v17, s[36:39], s47 offen  lds
buffer_load_dwordx4 v18, s[36:39], s47 offen offset:1024  lds
s_add_u32 m0, s40, 36864
s_nop 0
buffer_load_dwordx4 v19, s[36:39], s47 offen  lds
v_mfma_f32_16x16x32_bf16 v[72:75], v[144:147], v[112:115], v[72:75]
ds_read_b64_tr_b16 v[122:123], v58 offset:1152
ds_read_b64_tr_b16 v[124:125], v58 offset:32
v_mfma_f32_16x16x32_bf16 v[76:79], v[144:147], v[116:119], v[76:79]
ds_read_b64_tr_b16 v[126:127], v58 offset:1184
s_waitcnt lgkmcnt(8)
v_mfma_f32_16x16x32_bf16 v[80:83], v[148:151], v[112:115], v[80:83]
ds_read_b64_tr_b16 v[128:129], v58 offset:64
ds_read_b64_tr_b16 v[130:131], v58 offset:1216
v_mfma_f32_16x16x32_bf16 v[84:87], v[148:151], v[116:119], v[84:87]
ds_read_b64_tr_b16 v[132:133], v59 offset:0
v_mfma_f32_16x16x32_bf16 v[88:91], v[152:155], v[112:115], v[88:91]
ds_read_b64_tr_b16 v[134:135], v59 offset:1152
ds_read_b64_tr_b16 v[136:137], v59 offset:32
v_mfma_f32_16x16x32_bf16 v[92:95], v[152:155], v[116:119], v[92:95]
ds_read_b64_tr_b16 v[138:139], v59 offset:1184
s_waitcnt lgkmcnt(12)
v_mfma_f32_16x16x32_bf16 v[96:99], v[156:159], v[112:115], v[96:99]
v_mfma_f32_16x16x32_bf16 v[100:103], v[156:159], v[116:119], v[100:103]
s_waitcnt lgkmcnt(6)
v_mfma_f32_16x16x32_bf16 v[64:67], v[120:123], v[104:107], v[64:67]
ds_read_b128 v[112:115], v57 offset:0
ds_read_b128 v[116:119], v57 offset:2048
v_mfma_f32_16x16x32_bf16 v[68:71], v[120:123], v[108:111], v[68:71]
ds_read_b64_tr_b16 v[140:141], v58 offset:9728
v_mfma_f32_16x16x32_bf16 v[72:75], v[124:127], v[104:107], v[72:75]
ds_read_b64_tr_b16 v[142:143], v58 offset:10880
ds_read_b64_tr_b16 v[144:145], v58 offset:9760
v_mfma_f32_16x16x32_bf16 v[76:79], v[124:127], v[108:111], v[76:79]
ds_read_b64_tr_b16 v[146:147], v58 offset:10912
s_waitcnt lgkmcnt(8)
v_mfma_f32_16x16x32_bf16 v[80:83], v[128:131], v[104:107], v[80:83]
ds_read_b64_tr_b16 v[148:149], v58 offset:9792
ds_read_b64_tr_b16 v[150:151], v58 offset:10944
v_mfma_f32_16x16x32_bf16 v[84:87], v[128:131], v[108:111], v[84:87]
ds_read_b64_tr_b16 v[152:153], v59 offset:9728
v_mfma_f32_16x16x32_bf16 v[88:91], v[132:135], v[104:107], v[88:91]
ds_read_b64_tr_b16 v[154:155], v59 offset:10880
ds_read_b64_tr_b16 v[156:157], v59 offset:9760
v_mfma_f32_16x16x32_bf16 v[92:95], v[132:135], v[108:111], v[92:95]
ds_read_b64_tr_b16 v[158:159], v59 offset:10912
s_waitcnt lgkmcnt(12)
v_mfma_f32_16x16x32_bf16 v[96:99], v[136:139], v[104:107], v[96:99]
v_mfma_f32_16x16x32_bf16 v[100:103], v[136:139], v[108:111], v[100:103]
s_waitcnt vmcnt(5)
s_barrier
s_waitcnt lgkmcnt(6)
v_mfma_f32_16x16x32_bf16 v[64:67], v[140:143], v[112:115], v[64:67]
ds_read_b128 v[104:107], v44 offset:0
ds_read_b128 v[108:111], v44 offset:2048
v_mfma_f32_16x16x32_bf16 v[68:71], v[140:143], v[116:119], v[68:71]
ds_read_b64_tr_b16 v[120:121], v46 offset:0
s_add_u32 m0, s44, 73728
s_mul_i32 s47, s82, 1728
buffer_load_dwordx4 v16, s[32:35], s82 offen  lds
buffer_load_dwordx4 v22, s[32:35], s82 offen offset:1024  lds
s_add_u32 m0, s45, 73728
s_nop 0
buffer_load_dwordx4 v17, s[36:39], s47 offen  lds
buffer_load_dwordx4 v18, s[36:39], s47 offen offset:1024  lds
s_add_u32 m0, s40, 73728
s_nop 0
buffer_load_dwordx4 v19, s[36:39], s47 offen  lds
s_mov_b32 s60, s24
s_mov_b32 s61, s25
s_mov_b32 s62, 0x100
s_mov_b32 s63, 0x20000
v_mov_b32 v240, 0
buffer_load_dword v239, v240, s[60:63], 0 offen sc1
v_mfma_f32_16x16x32_bf16 v[72:75], v[144:147], v[112:115], v[72:75]
ds_read_b64_tr_b16 v[122:123], v46 offset:1152
ds_read_b64_tr_b16 v[124:125], v46 offset:32
v_mfma_f32_16x16x32_bf16 v[76:79], v[144:147], v[116:119], v[76:79]
ds_read_b64_tr_b16 v[126:127], v46 offset:1184
s_waitcnt lgkmcnt(8)
v_mfma_f32_16x16x32_bf16 v[80:83], v[148:151], v[112:115], v[80:83]
ds_read_b64_tr_b16 v[128:129], v46 offset:64
ds_read_b64_tr_b16 v[130:131], v46 offset:1216
v_mfma_f32_16x16x32_bf16 v[84:87], v[148:151], v[116:119], v[84:87]
ds_read_b64_tr_b16 v[132:133], v47 offset:0
v_mfma_f32_16x16x32_bf16 v[88:91], v[152:155], v[112:115], v[88:91]
ds_read_b64_tr_b16 v[134:135], v47 offset:1152
ds_read_b64_tr_b16 v[136:137], v47 offset:32
v_mfma_f32_16x16x32_bf16 v[92:95], v[152:155], v[116:119], v[92:95]
ds_read_b64_tr_b16 v[138:139], v47 offset:1184
s_waitcnt lgkmcnt(12)
v_mfma_f32_16x16x32_bf16 v[96:99], v[156:159], v[112:115], v[96:99]
v_mfma_f32_16x16x32_bf16 v[100:103], v[156:159], v[116:119], v[100:103]
s_waitcnt lgkmcnt(6)
v_mfma_f32_16x16x32_bf16 v[64:67], v[120:123], v[104:107], v[64:67]
ds_read_b128 v[112:115], v45 offset:0
ds_read_b128 v[116:119], v45 offset:2048
v_mfma_f32_16x16x32_bf16 v[68:71], v[120:123], v[108:111], v[68:71]
ds_read_b64_tr_b16 v[140:141], v46 offset:9728
v_mfma_f32_16x16x32_bf16 v[72:75], v[124:127], v[104:107], v[72:75]
ds_read_b64_tr_b16 v[142:143], v46 offset:10880
ds_read_b64_tr_b16 v[144:145], v46 offset:9760
v_mfma_f32_16x16x32_bf16 v[76:79], v[124:127], v[108:111], v[76:79]
ds_read_b64_tr_b16 v[146:147], v46 offset:10912
s_waitcnt lgkmcnt(8)
v_mfma_f32_16x16x32_bf16 v[80:83], v[128:131], v[104:107], v[80:83]
ds_read_b64_tr_b16 v[148:149], v46 offset:9792
ds_read_b64_tr_b16 v[150:151], v46 offset:10944
v_mfma_f32_16x16x32_bf16 v[84:87], v[128:131], v[108:111], v[84:87]
ds_read_b64_tr_b16 v[152:153], v47 offset:9728
v_mfma_f32_16x16x32_bf16 v[88:91], v[132:135], v[104:107], v[88:91]
ds_read_b64_tr_b16 v[154:155], v47 offset:10880
ds_read_b64_tr_b16 v[156:157], v47 offset:9760
v_mfma_f32_16x16x32_bf16 v[92:95], v[132:135], v[108:111], v[92:95]
ds_read_b64_tr_b16 v[158:159], v47 offset:10912
s_waitcnt lgkmcnt(12)
v_mfma_f32_16x16x32_bf16 v[96:99], v[136:139], v[104:107], v[96:99]
v_mfma_f32_16x16x32_bf16 v[100:103], v[136:139], v[108:111], v[100:103]
s_waitcnt vmcnt(6)
s_barrier
s_waitcnt lgkmcnt(6)
v_mfma_f32_16x16x32_bf16 v[64:67], v[140:143], v[112:115], v[64:67]
ds_read_b128 v[104:107], v48 offset:0
ds_read_b128 v[108:111], v48 offset:2048
v_mfma_f32_16x16x32_bf16 v[68:71], v[140:143], v[116:119], v[68:71]
ds_read_b64_tr_b16 v[120:121], v50 offset:0
s_add_u32 m0, s44, 110592
s_mul_i32 s47, s83, 1728
buffer_load_dwordx4 v16, s[32:35], s83 offen  lds
buffer_load_dwordx4 v22, s[32:35], s83 offen offset:1024  lds
s_add_u32 m0, s45, 110592
s_nop 0
buffer_load_dwordx4 v17, s[36:39], s47 offen  lds
buffer_load_dwordx4 v18, s[36:39], s47 offen offset:1024  lds
s_add_u32 m0, s40, 110592
s_nop 0
buffer_load_dwordx4 v19, s[36:39], s47 offen  lds
v_mfma_f32_16x16x32_bf16 v[72:75], v[144:147], v[112:115], v[72:75]
ds_read_b64_tr_b16 v[122:123], v50 offset:1152
ds_read_b64_tr_b16 v[124:125], v50 offset:32
v_mfma_f32_16x16x32_bf16 v[76:79], v[144:147], v[116:119], v[76:79]
ds_read_b64_tr_b16 v[126:127], v50 offset:1184
s_waitcnt lgkmcnt(8)
v_mfma_f32_16x16x32_bf16 v[80:83], v[148:151], v[112:115], v[80:83]
ds_read_b64_tr_b16 v[128:129], v50 offset:64
ds_read_b64_tr_b16 v[130:131], v50 offset:1216
v_mfma_f32_16x16x32_bf16 v[84:87], v[148:151], v[116:119], v[84:87]
ds_read_b64_tr_b16 v[132:133], v51 offset:0
v_mfma_f32_16x16x32_bf16 v[88:91], v[152:155], v[112:115], v[88:91]
ds_read_b64_tr_b16 v[134:135], v51 offset:1152
ds_read_b64_tr_b16 v[136:137], v51 offset:32
v_mfma_f32_16x16x32_bf16 v[92:95], v[152:155], v[116:119], v[92:95]
ds_read_b64_tr_b16 v[138:139], v51 offset:1184
s_waitcnt lgkmcnt(12)
v_mfma_f32_16x16x32_bf16 v[96:99], v[156:159], v[112:115], v[96:99]
v_mfma_f32_16x16x32_bf16 v[100:103], v[156:159], v[116:119], v[100:103]
s_waitcnt lgkmcnt(6)
v_mfma_f32_16x16x32_bf16 v[64:67], v[120:123], v[104:107], v[64:67]
ds_read_b128 v[112:115], v49 offset:0
ds_read_b128 v[116:119], v49 offset:2048
v_mfma_f32_16x16x32_bf16 v[68:71], v[120:123], v[108:111], v[68:71]
ds_read_b64_tr_b16 v[140:141], v50 offset:9728
v_mfma_f32_16x16x32_bf16 v[72:75], v[124:127], v[104:107], v[72:75]
ds_read_b64_tr_b16 v[142:143], v50 offset:10880
ds_read_b64_tr_b16 v[144:145], v50 offset:9760
v_mfma_f32_16x16x32_bf16 v[76:79], v[124:127], v[108:111], v[76:79]
ds_read_b64_tr_b16 v[146:147], v50 offset:10912
s_waitcnt lgkmcnt(8)
v_mfma_f32_16x16x32_bf16 v[80:83], v[128:131], v[104:107], v[80:83]
ds_read_b64_tr_b16 v[148:149], v50 offset:9792
ds_read_b64_tr_b16 v[150:151], v50 offset:10944
v_mfma_f32_16x16x32_bf16 v[84:87], v[128:131], v[108:111], v[84:87]
ds_read_b64_tr_b16 v[152:153], v51 offset:9728
v_mfma_f32_16x16x32_bf16 v[88:91], v[132:135], v[104:107], v[88:91]
ds_read_b64_tr_b16 v[154:155], v51 offset:10880
ds_read_b64_tr_b16 v[156:157], v51 offset:9760
v_mfma_f32_16x16x32_bf16 v[92:95], v[132:135], v[108:111], v[92:95]
ds_read_b64_tr_b16 v[158:159], v51 offset:10912
s_waitcnt lgkmcnt(12)
v_mfma_f32_16x16x32_bf16 v[96:99], v[136:139], v[104:107], v[96:99]
v_mfma_f32_16x16x32_bf16 v[100:103], v[136:139], v[108:111], v[100:103]
s_waitcnt vmcnt(6)
s_barrier
s_waitcnt lgkmcnt(6)
v_mfma_f32_16x16x32_bf16 v[64:67], v[140:143], v[112:115], v[64:67]
ds_read_b128 v[104:107], v52 offset:0
ds_read_b128 v[108:111], v52 offset:2048
v_mfma_f32_16x16x32_bf16 v[68:71], v[140:143], v[116:119], v[68:71]
ds_read_b64_tr_b16 v[120:121], v54 offset:0
s_add_u32 m0, s44, 0
s_mul_i32 s47, s84, 1728
buffer_load_dwordx4 v16, s[32:35], s84 offen  lds
buffer_load_dwordx4 v22, s[32:35], s84 offen offset:1024  lds
s_add_u32 m0, s45, 0
s_nop 0
buffer_load_dwordx4 v17, s[36:39], s47 offen  lds
buffer_load_dwordx4 v18, s[36:39], s47 offen offset:1024  lds
s_add_u32 m0, s40, 0
s_nop 0
buffer_load_dwordx4 v19, s[36:39], s47 offen  lds
v_mfma_f32_16x16x32_bf16 v[72:75], v[144:147], v[112:115], v[72:75]
ds_read_b64_tr_b16 v[122:123], v54 offset:1152
ds_read_b64_tr_b16 v[124:125], v54 offset:32
v_mfma_f32_16x16x32_bf16 v[76:79], v[144:147], v[116:119], v[76:79]
ds_read_b64_tr_b16 v[126:127], v54 offset:1184
s_waitcnt lgkmcnt(8)
v_mfma_f32_16x16x32_bf16 v[80:83], v[148:151], v[112:115], v[80:83]
ds_read_b64_tr_b16 v[128:129], v54 offset:64
ds_read_b64_tr_b16 v[130:131], v54 offset:1216
v_mfma_f32_16x16x32_bf16 v[84:87], v[148:151], v[116:119], v[84:87]
ds_read_b64_tr_b16 v[132:133], v55 offset:0
v_mfma_f32_16x16x32_bf16 v[88:91], v[152:155], v[112:115], v[88:91]
ds_read_b64_tr_b16 v[134:135], v55 offset:1152
ds_read_b64_tr_b16 v[136:137], v55 offset:32
v_mfma_f32_16x16x32_bf16 v[92:95], v[152:155], v[116:119], v[92:95]
ds_read_b64_tr_b16 v[138:139], v55 offset:1184
s_waitcnt lgkmcnt(12)
v_mfma_f32_16x16x32_bf16 v[96:99], v[156:159], v[112:115], v[96:99]
v_mfma_f32_16x16x32_bf16 v[100:103], v[156:159], v[116:119], v[100:103]
s_waitcnt lgkmcnt(6)
v_mfma_f32_16x16x32_bf16 v[64:67], v[120:123], v[104:107], v[64:67]
ds_read_b128 v[112:115], v53 offset:0
ds_read_b128 v[116:119], v53 offset:2048
v_mfma_f32_16x16x32_bf16 v[68:71], v[120:123], v[108:111], v[68:71]
ds_read_b64_tr_b16 v[140:141], v54 offset:9728
v_mfma_f32_16x16x32_bf16 v[72:75], v[124:127], v[104:107], v[72:75]
ds_read_b64_tr_b16 v[142:143], v54 offset:10880
ds_read_b64_tr_b16 v[144:145], v54 offset:9760
v_mfma_f32_16x16x32_bf16 v[76:79], v[124:127], v[108:111], v[76:79]
ds_read_b64_tr_b16 v[146:147], v54 offset:10912
s_waitcnt lgkmcnt(8)
v_mfma_f32_16x16x32_bf16 v[80:83], v[128:131], v[104:107], v[80:83]
ds_read_b64_tr_b16 v[148:149], v54 offset:9792
ds_read_b64_tr_b16 v[150:151], v54 offset:10944
v_mfma_f32_16x16x32_bf16 v[84:87], v[128:131], v[108:111], v[84:87]
ds_read_b64_tr_b16 v[152:153], v55 offset:9728
v_mfma_f32_16x16x32_bf16 v[88:91], v[132:135], v[104:107], v[88:91]
ds_read_b64_tr_b16 v[154:155], v55 offset:10880
ds_read_b64_tr_b16 v[156:157], v55 offset:9760
v_mfma_f32_16x16x32_bf16 v[92:95], v[132:135], v[108:111], v[92:95]
ds_read_b64_tr_b16 v[158:159], v55 offset:10912
s_waitcnt lgkmcnt(12)
v_mfma_f32_16x16x32_bf16 v[96:99], v[136:139], v[104:107], v[96:99]
v_mfma_f32_16x16x32_bf16 v[100:103], v[136:139], v[108:111], v[100:103]
s_waitcnt vmcnt(5)
s_barrier
s_waitcnt lgkmcnt(6)
v_mfma_f32_16x16x32_bf16 v[64:67], v[140:143], v[112:115], v[64:67]
ds_read_b128 v[104:107], v56 offset:0
ds_read_b128 v[108:111], v56 offset:2048
v_mfma_f32_16x16x32_bf16 v[68:71], v[140:143], v[116:119], v[68:71]
ds_read_b64_tr_b16 v[120:121], v58 offset:0
v_mfma_f32_16x16x32_bf16 v[72:75], v[144:147], v[112:115], v[72:75]
ds_read_b64_tr_b16 v[122:123], v58 offset:1152
ds_read_b64_tr_b16 v[124:125], v58 offset:32
v_mfma_f32_16x16x32_bf16 v[76:79], v[144:147], v[116:119], v[76:79]
ds_read_b64_tr_b16 v[126:127], v58 offset:1184
s_waitcnt lgkmcnt(8)
v_mfma_f32_16x16x32_bf16 v[80:83], v[148:151], v[112:115], v[80:83]
ds_read_b64_tr_b16 v[128:129], v58 offset:64
ds_read_b64_tr_b16 v[130:131], v58 offset:1216
v_mfma_f32_16x16x32_bf16 v[84:87], v[148:151], v[116:119], v[84:87]
ds_read_b64_tr_b16 v[132:133], v59 offset:0
v_mfma_f32_16x16x32_bf16 v[88:91], v[152:155], v[112:115], v[88:91]
ds_read_b64_tr_b16 v[134:135], v59 offset:1152
ds_read_b64_tr_b16 v[136:137], v59 offset:32
v_mfma_f32_16x16x32_bf16 v[92:95], v[152:155], v[116:119], v[92:95]
ds_read_b64_tr_b16 v[138:139], v59 offset:1184
s_waitcnt lgkmcnt(12)
v_mfma_f32_16x16x32_bf16 v[96:99], v[156:159], v[112:115], v[96:99]
v_mfma_f32_16x16x32_bf16 v[100:103], v[156:159], v[116:119], v[100:103]
s_waitcnt lgkmcnt(6)
v_mfma_f32_16x16x32_bf16 v[64:67], v[120:123], v[104:107], v[64:67]
ds_read_b128 v[112:115], v57 offset:0
ds_read_b128 v[116:119], v57 offset:2048
v_mfma_f32_16x16x32_bf16 v[68:71], v[120:123], v[108:111], v[68:71]
ds_read_b64_tr_b16 v[140:141], v58 offset:9728
v_mfma_f32_16x16x32_bf16 v[72:75], v[124:127], v[104:107], v[72:75]
ds_read_b64_tr_b16 v[142:143], v58 offset:10880
ds_read_b64_tr_b16 v[144:145], v58 offset:9760
v_mfma_f32_16x16x32_bf16 v[76:79], v[124:127], v[108:111], v[76:79]
ds_read_b64_tr_b16 v[146:147], v58 offset:10912
s_waitcnt lgkmcnt(8)
v_mfma_f32_16x16x32_bf16 v[80:83], v[128:131], v[104:107], v[80:83]
ds_read_b64_tr_b16 v[148:149], v58 offset:9792
ds_read_b64_tr_b16 v[150:151], v58 offset:10944
v_mfma_f32_16x16x32_bf16 v[84:87], v[128:131], v[108:111], v[84:87]
ds_read_b64_tr_b16 v[152:153], v59 offset:9728
v_mfma_f32_16x16x32_bf16 v[88:91], v[132:135], v[104:107], v[88:91]
ds_read_b64_tr_b16 v[154:155], v59 offset:10880
ds_read_b64_tr_b16 v[156:157], v59 offset:9760
v_mfma_f32_16x16x32_bf16 v[92:95], v[132:135], v[108:111], v[92:95]
ds_read_b64_tr_b16 v[158:159], v59 offset:10912
s_waitcnt lgkmcnt(12)
v_mfma_f32_16x16x32_bf16 v[96:99], v[136:139], v[104:107], v[96:99]
v_mfma_f32_16x16x32_bf16 v[100:103], v[136:139], v[108:111], v[100:103]
s_waitcnt vmcnt(0)
s_barrier
s_waitcnt lgkmcnt(6)
v_mfma_f32_16x16x32_bf16 v[64:67], v[140:143], v[112:115], v[64:67]
ds_read_b128 v[104:107], v44 offset:0
ds_read_b128 v[108:111], v44 offset:2048
v_mfma_f32_16x16x32_bf16 v[68:71], v[140:143], v[116:119], v[68:71]
ds_read_b64_tr_b16 v[120:121], v46 offset:0
v_mfma_f32_16x16x32_bf16 v[72:75], v[144:147], v[112:115], v[72:75]
ds_read_b64_tr_b16 v[122:123], v46 offset:1152
ds_read_b64_tr_b16 v[124:125], v46 offset:32
v_mfma_f32_16x16x32_bf16 v[76:79], v[144:147], v[116:119], v[76:79]
ds_read_b64_tr_b16 v[126:127], v46 offset:1184
s_waitcnt lgkmcnt(8)
v_mfma_f32_16x16x32_bf16 v[80:83], v[148:151], v[112:115], v[80:83]
ds_read_b64_tr_b16 v[128:129], v46 offset:64
ds_read_b64_tr_b16 v[130:131], v46 offset:1216
v_mfma_f32_16x16x32_bf16 v[84:87], v[148:151], v[116:119], v[84:87]
ds_read_b64_tr_b16 v[132:133], v47 offset:0
v_mfma_f32_16x16x32_bf16 v[88:91], v[152:155], v[112:115], v[88:91]
ds_read_b64_tr_b16 v[134:135], v47 offset:1152
ds_read_b64_tr_b16 v[136:137], v47 offset:32
v_mfma_f32_16x16x32_bf16 v[92:95], v[152:155], v[116:119], v[92:95]
ds_read_b64_tr_b16 v[138:139], v47 offset:1184
s_waitcnt lgkmcnt(12)
v_mfma_f32_16x16x32_bf16 v[96:99], v[156:159], v[112:115], v[96:99]
v_mfma_f32_16x16x32_bf16 v[100:103], v[156:159], v[116:119], v[100:103]
s_waitcnt lgkmcnt(6)
v_mfma_f32_16x16x32_bf16 v[64:67], v[120:123], v[104:107], v[64:67]
ds_read_b128 v[112:115], v45 offset:0
ds_read_b128 v[116:119], v45 offset:2048
v_mfma_f32_16x16x32_bf16 v[68:71], v[120:123], v[108:111], v[68:71]
ds_read_b64_tr_b16 v[140:141], v46 offset:9728
v_mfma_f32_16x16x32_bf16 v[72:75], v[124:127], v[104:107], v[72:75]
ds_read_b64_tr_b16 v[142:143], v46 offset:10880
ds_read_b64_tr_b16 v[144:145], v46 offset:9760
v_mfma_f32_16x16x32_bf16 v[76:79], v[124:127], v[108:111], v[76:79]
ds_read_b64_tr_b16 v[146:147], v46 offset:10912
s_waitcnt lgkmcnt(8)
v_mfma_f32_16x16x32_bf16 v[80:83], v[128:131], v[104:107], v[80:83]
ds_read_b64_tr_b16 v[148:149], v46 offset:9792
ds_read_b64_tr_b16 v[150:151], v46 offset:10944
v_mfma_f32_16x16x32_bf16 v[84:87], v[128:131], v[108:111], v[84:87]
ds_read_b64_tr_b16 v[152:153], v47 offset:9728
v_mfma_f32_16x16x32_bf16 v[88:91], v[132:135], v[104:107], v[88:91]
ds_read_b64_tr_b16 v[154:155], v47 offset:10880
ds_read_b64_tr_b16 v[156:157], v47 offset:9760
v_mfma_f32_16x16x32_bf16 v[92:95], v[132:135], v[108:111], v[92:95]
ds_read_b64_tr_b16 v[158:159], v47 offset:10912
s_waitcnt lgkmcnt(12)
v_mfma_f32_16x16x32_bf16 v[96:99], v[136:139], v[104:107], v[96:99]
v_mfma_f32_16x16x32_bf16 v[100:103], v[136:139], v[108:111], v[100:103]
s_waitcnt lgkmcnt(6)
v_mfma_f32_16x16x32_bf16 v[64:67], v[140:143], v[112:115], v[64:67]
v_mfma_f32_16x16x32_bf16 v[68:71], v[140:143], v[116:119], v[68:71]
v_mfma_f32_16x16x32_bf16 v[72:75], v[144:147], v[112:115], v[72:75]
v_mfma_f32_16x16x32_bf16 v[76:79], v[144:147], v[116:119], v[76:79]
s_waitcnt lgkmcnt(2)
v_mfma_f32_16x16x32_bf16 v[80:83], v[148:151], v[112:115], v[80:83]
v_mfma_f32_16x16x32_bf16 v[84:87], v[148:151], v[116:119], v[84:87]
v_mfma_f32_16x16x32_bf16 v[88:91], v[152:155], v[112:115], v[88:91]
v_mfma_f32_16x16x32_bf16 v[92:95], v[152:155], v[116:119], v[92:95]
s_waitcnt lgkmcnt(0)
v_mfma_f32_16x16x32_bf16 v[96:99], v[156:159], v[112:115], v[96:99]
v_mfma_f32_16x16x32_bf16 v[100:103], v[156:159], v[116:119], v[100:103]
v_readfirstlane_b32 s70, v239
s_nop 0
s_cmp_lg_u32 s70, 0
s_cbranch_scc1 Ltr_27
s_mov_b32 s60, s24
s_mov_b32 s61, s25
s_mov_b32 s62, 0x100
s_mov_b32 s63, 0x20000
v_mov_b32 v240, 0
buffer_load_dword v239, v240, s[60:63], 0 offen sc1
s_waitcnt vmcnt(0)
v_readfirstlane_b32 s70, v239
s_nop 0
s_cmp_lg_u32 s70, 0
s_cbranch_scc1 Lnf_28
s_mov_b32 s60, s24
s_mov_b32 s61, s25
s_mov_b32 s62, 0x100
s_mov_b32 s63, 0x20000
s_mov_b32 s69, 0
v_mov_b32 v240, 0
Lnq_29:
buffer_load_dword v239, v240, s[60:63], 0 offen sc1
s_add_u32 s69, s69, 1
s_waitcnt vmcnt(0)
v_readfirstlane_b32 s70, v239
s_cmp_ge_u32 s69, 100000
s_cbranch_scc1 Lnf_28
s_cmp_eq_u32 s70, 0
s_cbranch_scc1 Lnq_29
Lnf_28:
Ltr_27:
s_mul_i32 s92, s70, 0x9E3779B1
s_mov_b32 s56, 0x3fb8aa3b
s_mov_b32 s57, 0x3fb8aa3b
s_mov_b32 s58, 0x358637bd
s_mov_b32 s59, 0x358637bd
v_pk_mul_f32 v[104:105], v[64:65], s[56:57]
v_pk_mul_f32 v[106:107], v[66:67], s[56:57]
v_pk_mul_f32 v[108:109], v[68:69], s[56:57]
v_pk_mul_f32 v[110:111], v[70:71], s[56:57]
v_exp_f32 v104, v104 clamp
v_exp_f32 v105, v105 clamp
v_exp_f32 v106, v106 clamp
v_exp_f32 v107, v107 clamp
v_exp_f32 v108, v108 clamp
v_exp_f32 v109, v109 clamp
v_exp_f32 v110, v110 clamp
v_exp_f32 v111, v111 clamp
v_max_f32 v64, 0, v64
v_max_f32 v65, 0, v65
v_max_f32 v66, 0, v66
v_max_f32 v67, 0, v67
v_max_f32 v68, 0, v68
v_max_f32 v69, 0, v69
v_max_f32 v70, 0, v70
v_max_f32 v71, 0, v71
v_pk_add_f32 v[104:105], v[104:105], s[58:59]
v_pk_add_f32 v[106:107], v[106:107], s[58:59]
v_pk_add_f32 v[108:109], v[108:109], s[58:59]
v_pk_add_f32 v[110:111], v[110:111], s[58:59]
v_pk_add_f32 v[64:65], v[64:65], v[104:105]
v_pk_add_f32 v[66:67], v[66:67], v[106:107]
v_pk_add_f32 v[68:69], v[68:69], v[108:109]
v_pk_add_f32 v[70:71], v[70:71], v[110:111]
v_pk_mul_f32 v[104:105], v[72:73], s[56:57]
v_pk_mul_f32 v[106:107], v[74:75], s[56:57]
v_pk_mul_f32 v[108:109], v[76:77], s[56:57]
v_pk_mul_f32 v[110:111], v[78:79], s[56:57]
v_exp_f32 v104, v104 clamp
v_exp_f32 v105, v105 clamp
v_exp_f32 v106, v106 clamp
v_exp_f32 v107, v107 clamp
v_exp_f32 v108, v108 clamp
v_exp_f32 v109, v109 clamp
v_exp_f32 v110, v110 clamp
v_exp_f32 v111, v111 clamp
v_max_f32 v72, 0, v72
v_max_f32 v73, 0, v73
v_max_f32 v74, 0, v74
v_max_f32 v75, 0, v75
v_max_f32 v76, 0, v76
v_max_f32 v77, 0, v77
v_max_f32 v78, 0, v78
v_max_f32 v79, 0, v79
v_pk_add_f32 v[104:105], v[104:105], s[58:59]
v_pk_add_f32 v[106:107], v[106:107], s[58:59]
v_pk_add_f32 v[108:109], v[108:109], s[58:59]
v_pk_add_f32 v[110:111], v[110:111], s[58:59]
v_pk_add_f32 v[72:73], v[72:73], v[104:105]
v_pk_add_f32 v[74:75], v[74:75], v[106:107]
v_pk_add_f32 v[76:77], v[76:77], v[108:109]
v_pk_add_f32 v[78:79], v[78:79], v[110:111]
v_pk_mul_f32 v[104:105], v[80:81], s[56:57]
v_pk_mul_f32 v[106:107], v[82:83], s[56:57]
v_pk_mul_f32 v[108:109], v[84:85], s[56:57]
v_pk_mul_f32 v[110:111], v[86:87], s[56:57]
v_exp_f32 v104, v104 clamp
v_exp_f32 v105, v105 clamp
v_exp_f32 v106, v106 clamp
v_exp_f32 v107, v107 clamp
v_exp_f32 v108, v108 clamp
v_exp_f32 v109, v109 clamp
v_exp_f32 v110, v110 clamp
v_exp_f32 v111, v111 clamp
v_max_f32 v80, 0, v80
v_max_f32 v81, 0, v81
v_max_f32 v82, 0, v82
v_max_f32 v83, 0, v83
v_max_f32 v84, 0, v84
v_max_f32 v85, 0, v85
v_max_f32 v86, 0, v86
v_max_f32 v87, 0, v87
v_pk_add_f32 v[104:105], v[104:105], s[58:59]
v_pk_add_f32 v[106:107], v[106:107], s[58:59]
v_pk_add_f32 v[108:109], v[108:109], s[58:59]
v_pk_add_f32 v[110:111], v[110:111], s[58:59]
v_pk_add_f32 v[80:81], v[80:81], v[104:105]
v_pk_add_f32 v[82:83], v[82:83], v[106:107]
v_pk_add_f32 v[84:85], v[84:85], v[108:109]
v_pk_add_f32 v[86:87], v[86:87], v[110:111]
v_pk_mul_f32 v[104:105], v[88:89], s[56:57]
v_pk_mul_f32 v[106:107], v[90:91], s[56:57]
v_pk_mul_f32 v[108:109], v[92:93], s[56:57]
v_pk_mul_f32 v[110:111], v[94:95], s[56:57]
v_exp_f32 v104, v104 clamp
v_exp_f32 v105, v105 clamp
v_exp_f32 v106, v106 clamp
v_exp_f32 v107, v107 clamp
v_exp_f32 v108, v108 clamp
v_exp_f32 v109, v109 clamp
v_exp_f32 v110, v110 clamp
v_exp_f32 v111, v111 clamp
v_max_f32 v88, 0, v88
v_max_f32 v89, 0, v89
v_max_f32 v90, 0, v90
v_max_f32 v91, 0, v91
v_max_f32 v92, 0, v92
v_max_f32 v93, 0, v93
v_max_f32 v94, 0, v94
v_max_f32 v95, 0, v95
v_pk_add_f32 v[104:105], v[104:105], s[58:59]
v_pk_add_f32 v[106:107], v[106:107], s[58:59]
v_pk_add_f32 v[108:109], v[108:109], s[58:59]
v_pk_add_f32 v[110:111], v[110:111], s[58:59]
v_pk_add_f32 v[88:89], v[88:89], v[104:105]
v_pk_add_f32 v[90:91], v[90:91], v[106:107]
v_pk_add_f32 v[92:93], v[92:93], v[108:109]
v_pk_add_f32 v[94:95], v[94:95], v[110:111]
v_pk_mul_f32 v[104:105], v[96:97], s[56:57]
v_pk_mul_f32 v[106:107], v[98:99], s[56:57]
v_pk_mul_f32 v[108:109], v[100:101], s[56:57]
v_pk_mul_f32 v[110:111], v[102:103], s[56:57]
v_exp_f32 v104, v104 clamp
v_exp_f32 v105, v105 clamp
v_exp_f32 v106, v106 clamp
v_exp_f32 v107, v107 clamp
v_exp_f32 v108, v108 clamp
v_exp_f32 v109, v109 clamp
v_exp_f32 v110, v110 clamp
v_exp_f32 v111, v111 clamp
v_max_f32 v96, 0, v96
v_max_f32 v97, 0, v97
v_max_f32 v98, 0, v98
v_max_f32 v99, 0, v99
v_max_f32 v100, 0, v100
v_max_f32 v101, 0, v101
v_max_f32 v102, 0, v102
v_max_f32 v103, 0, v103
v_pk_add_f32 v[104:105], v[104:105], s[58:59]
v_pk_add_f32 v[106:107], v[106:107], s[58:59]
v_pk_add_f32 v[108:109], v[108:109], s[58:59]
v_pk_add_f32 v[110:111], v[110:111], s[58:59]
v_pk_add_f32 v[96:97], v[96:97], v[104:105]
v_pk_add_f32 v[98:99], v[98:99], v[106:107]
v_pk_add_f32 v[100:101], v[100:101], v[108:109]
v_pk_add_f32 v[102:103], v[102:103], v[110:111]
v_cvt_pk_bf16_f32 v120, v64, v65
v_cvt_pk_bf16_f32 v121, v66, v67
v_cvt_pk_bf16_f32 v122, v72, v73
v_cvt_pk_bf16_f32 v123, v74, v75
v_cvt_pk_bf16_f32 v124, v80, v81
v_cvt_pk_bf16_f32 v125, v82, v83
v_cvt_pk_bf16_f32 v126, v88, v89
v_cvt_pk_bf16_f32 v127, v90, v91
v_cvt_pk_bf16_f32 v128, v96, v97
v_cvt_pk_bf16_f32 v129, v98, v99
v_mov_b32 v130, 0
v_mov_b32 v131, 0
v_cvt_pk_bf16_f32 v132, v68, v69
v_cvt_pk_bf16_f32 v133, v70, v71
v_cvt_pk_bf16_f32 v134, v76, v77
v_cvt_pk_bf16_f32 v135, v78, v79
v_cvt_pk_bf16_f32 v136, v84, v85
v_cvt_pk_bf16_f32 v137, v86, v87
v_cvt_pk_bf16_f32 v138, v92, v93
v_cvt_pk_bf16_f32 v139, v94, v95
v_cvt_pk_bf16_f32 v140, v100, v101
v_cvt_pk_bf16_f32 v141, v102, v103
v_mov_b32 v142, 0
v_mov_b32 v143, 0
s_lshr_b32 s41, s28, 2
s_lshl_b32 s42, s30, 1
s_add_u32 s42, s42, s41
s_mul_i32 s42, s42, 270336
s_add_u32 s48, s42, 4734976
v_and_b32 v2, 15, v0
v_lshrrev_b32 v3, 4, v0
v_mul_u32_u24 v4, 16896, v2
v_lshl_add_u32 v4, v3, 4, v4
v_and_b32 v5, 3, v2
v_mul_u32_u24 v5, 18, v5
v_lshlrev_b32 v6, 2, v3
v_sub_u32 v5, v6, v5
v_add_u32 v6, 0, v5
v_cmp_gt_u32 vcc, 18, v6
s_nop 1
v_cndmask_b32 v192, 0, 1.0, vcc
v_add_u32 v6, 1, v5
v_cmp_gt_u32 vcc, 18, v6
s_nop 1
v_cndmask_b32 v193, 0, 1.0, vcc
v_add_u32 v6, 2, v5
v_cmp_gt_u32 vcc, 18, v6
s_nop 1
v_cndmask_b32 v194, 0, 1.0, vcc
v_add_u32 v6, 3, v5
v_cmp_gt_u32 vcc, 18, v6
s_nop 1
v_cndmask_b32 v195, 0, 1.0, vcc
v_add_u32 v6, 16, v5
v_cmp_gt_u32 vcc, 18, v6
s_nop 1
v_cndmask_b32 v196, 0, 1.0, vcc
v_add_u32 v6, 17, v5
v_cmp_gt_u32 vcc, 18, v6
s_nop 1
v_cndmask_b32 v197, 0, 1.0, vcc
v_add_u32 v6, 18, v5
v_cmp_gt_u32 vcc, 18, v6
s_nop 1
v_cndmask_b32 v198, 0, 1.0, vcc
v_add_u32 v6, 19, v5
v_cmp_gt_u32 vcc, 18, v6
s_nop 1
v_cndmask_b32 v199, 0, 1.0, vcc
v_add_u32 v6, 32, v5
v_cmp_gt_u32 vcc, 18, v6
s_nop 1
v_cndmask_b32 v200, 0, 1.0, vcc
v_add_u32 v6, 33, v5
v_cmp_gt_u32 vcc, 18, v6
s_nop 1
v_cndmask_b32 v201, 0, 1.0, vcc
v_add_u32 v6, 34, v5
v_cmp_gt_u32 vcc, 18, v6
s_nop 1
v_cndmask_b32 v202, 0, 1.0, vcc
v_add_u32 v6, 35, v5
v_cmp_gt_u32 vcc, 18, v6
s_nop 1
v_cndmask_b32 v203, 0, 1.0, vcc
v_add_u32 v6, 48, v5
v_cmp_gt_u32 vcc, 18, v6
s_nop 1
v_cndmask_b32 v204, 0, 1.0, vcc
v_add_u32 v6, 49, v5
v_cmp_gt_u32 vcc, 18, v6
s_nop 1
v_cndmask_b32 v205, 0, 1.0, vcc
v_add_u32 v6, 50, v5
v_cmp_gt_u32 vcc, 18, v6
s_nop 1
v_cndmask_b32 v206, 0, 1.0, vcc
v_add_u32 v6, 51, v5
v_cmp_gt_u32 vcc, 18, v6
s_nop 1
v_cndmask_b32 v207, 0, 1.0, vcc
v_add_u32 v6, 64, v5
v_cmp_gt_u32 vcc, 18, v6
s_nop 1
v_cndmask_b32 v208, 0, 1.0, vcc
v_add_u32 v6, 65, v5
v_cmp_gt_u32 vcc, 18, v6
s_nop 1
v_cndmask_b32 v209, 0, 1.0, vcc
v_add_u32 v6, 66, v5
v_cmp_gt_u32 vcc, 18, v6
s_nop 1
v_cndmask_b32 v210, 0, 1.0, vcc
v_add_u32 v6, 67, v5
v_cmp_gt_u32 vcc, 18, v6
s_nop 1
v_cndmask_b32 v211, 0, 1.0, vcc
v_mov_b32 v174, 0
v_mov_b32 v175, 0
v_mov_b32 v176, s58
v_mov_b32 v177, s58
v_mov_b32 v178, s58
v_mov_b32 v179, s58
v_mov_b32 v180, s58
v_mov_b32 v181, s58
v_mov_b32 v182, s58
v_mov_b32 v183, s58
s_mov_b64 s[54:55], 0xffff
s_mov_b32 s56, -1
s_mov_b32 s57, 0
s_and_b32 s41, s28, 3
s_lshl_b32 s41, s41, 1
s_lshl_b32 s42, s29, 3
s_add_u32 s41, s41, s42
s_mul_i32 s41, s41, 18432
s_add_u32 s41, s41, 6881280
s_lshr_b32 s42, s28, 2
s_lshl_b32 s49, s30, 2
s_lshl_b32 s53, s42, 1
s_add_u32 s49, s49, s53
s_lshl_b32 s49, s49, 10
s_add_u32 s49, s49, s41
s_lshr_b32 s53, s30, 1
s_add_u32 s53, s53, 16
s_lshl_b32 s53, s53, 10
s_add_u32 s53, s53, s41
s_and_b32 s52, s30, 1
s_lshl_b32 s52, s52, 3
s_add_u32 s53, s53, s52
s_lshl_b32 s52, s42, 9
s_add_u32 s53, s53, s52
v_lshlrev_b32 v2, 4, v0
s_cmp_eq_u32 s28, 0
s_cbranch_scc0 Lwf_30
v_and_b32 v242, 31, v0
s_lshl_b32 s68, s30, 5
s_add_u32 s68, s68, 64
v_add_u32 v242, s68, v242
v_lshlrev_b32 v242, 7, v242
v_add_u32 v242, 10166272, v242
s_mov_b32 s69, 0
Lwp_31:
buffer_load_dword v243, v242, s[64:67], 0 offen sc1
s_add_u32 s69, s69, 1
s_waitcnt vmcnt(0)
v_cmp_ne_u32 vcc, s70, v243
s_cmp_ge_u32 s69, 100000
s_cbranch_scc1 Lwf_30
s_cmp_lg_u64 vcc, 0
s_cbranch_scc1 Lwp_31
Lwf_30:
s_barrier
s_mov_b32 s69, 0
v_bfe_u32 v216, s92, 0, 8
v_bfe_u32 v217, s92, 8, 8
v_bfe_u32 v218, s92, 16, 8
v_bfe_u32 v219, s92, 24, 8
Lzp_32:
buffer_load_dwordx4 v[144:147], v4, s[64:67], s48 offen offset:0 sc1
buffer_load_dwordx4 v[148:151], v4, s[64:67], s48 offen offset:64 sc1
buffer_load_dwordx4 v[152:155], v4, s[64:67], s48 offen offset:128 sc1
buffer_load_dwordx4 v[156:159], v4, s[64:67], s48 offen offset:192 sc1
buffer_load_dwordx4 v[160:163], v4, s[64:67], s48 offen offset:256 sc1
s_add_u32 s69, s69, 1
s_waitcnt vmcnt(4)
v_xor_b32 v220, v144, v216
v_xor_b32 v221, v145, v217
v_xor_b32 v222, v146, v218
v_xor_b32 v223, v147, v219
v_or3_b32 v224, v220, v221, v222
v_or_b32 v224, v224, v223
s_waitcnt vmcnt(3)
v_xor_b32 v220, v148, v216
v_xor_b32 v221, v149, v217
v_xor_b32 v222, v150, v218
v_xor_b32 v223, v151, v219
v_or3_b32 v224, v224, v220, v221
v_or3_b32 v224, v224, v222, v223
s_waitcnt vmcnt(2)
v_xor_b32 v220, v152, v216
v_xor_b32 v221, v153, v217
v_xor_b32 v222, v154, v218
v_xor_b32 v223, v155, v219
v_or3_b32 v224, v224, v220, v221
v_or3_b32 v224, v224, v222, v223
s_waitcnt vmcnt(1)
v_xor_b32 v220, v156, v216
v_xor_b32 v221, v157, v217
v_xor_b32 v222, v158, v218
v_xor_b32 v223, v159, v219
v_or3_b32 v224, v224, v220, v221
v_or3_b32 v224, v224, v222, v223
s_waitcnt vmcnt(0)
v_xor_b32 v220, v160, v216
v_xor_b32 v221, v161, v217
v_xor_b32 v222, v162, v218
v_xor_b32 v223, v163, v219
v_or3_b32 v224, v224, v220, v221
v_or3_b32 v224, v224, v222, v223
v_and_b32 v224, 0xff, v224
v_cmp_ne_u32 vcc, 0, v224
s_cmp_ge_u32 s69, 100000
s_cbranch_scc1 Lzo_33
s_cmp_lg_u64 vcc, 0
s_cbranch_scc1 Lzp_32
Lzo_33:
v_add_f32_dpp v144, v144, v144 row_ror:8 row_mask:0xf bank_mask:0xf
v_add_f32_dpp v145, v145, v145 row_ror:8 row_mask:0xf bank_mask:0xf
v_add_f32_dpp v146, v146, v146 row_ror:8 row_mask:0xf bank_mask:0xf
v_add_f32_dpp v147, v147, v147 row_ror:8 row_mask:0xf bank_mask:0xf
v_add_f32_dpp v148, v148, v148 row_ror:8 row_mask:0xf bank_mask:0xf
v_add_f32_dpp v149, v149, v149 row_ror:8 row_mask:0xf bank_mask:0xf
v_add_f32_dpp v150, v150, v150 row_ror:8 row_mask:0xf bank_mask:0xf
v_add_f32_dpp v151, v151, v151 row_ror:8 row_mask:0xf bank_mask:0xf
v_add_f32_dpp v152, v152, v152 row_ror:8 row_mask:0xf bank_mask:0xf
v_add_f32_dpp v153, v153, v153 row_ror:8 row_mask:0xf bank_mask:0xf
v_add_f32_dpp v154, v154, v154 row_ror:8 row_mask:0xf bank_mask:0xf
v_add_f32_dpp v155, v155, v155 row_ror:8 row_mask:0xf bank_mask:0xf
v_add_f32_dpp v156, v156, v156 row_ror:8 row_mask:0xf bank_mask:0xf
v_add_f32_dpp v157, v157, v157 row_ror:8 row_mask:0xf bank_mask:0xf
v_add_f32_dpp v158, v158, v158 row_ror:8 row_mask:0xf bank_mask:0xf
v_add_f32_dpp v159, v159, v159 row_ror:8 row_mask:0xf bank_mask:0xf
v_add_f32_dpp v160, v160, v160 row_ror:8 row_mask:0xf bank_mask:0xf
v_add_f32_dpp v161, v161, v161 row_ror:8 row_mask:0xf bank_mask:0xf
v_add_f32_dpp v162, v162, v162 row_ror:8 row_mask:0xf bank_mask:0xf
v_add_f32_dpp v163, v163, v163 row_ror:8 row_mask:0xf bank_mask:0xf
v_add_f32_dpp v144, v144, v144 row_ror:4 row_mask:0xf bank_mask:0xf
v_add_f32_dpp v145, v145, v145 row_ror:4 row_mask:0xf bank_mask:0xf
v_add_f32_dpp v146, v146, v146 row_ror:4 row_mask:0xf bank_mask:0xf
v_add_f32_dpp v147, v147, v147 row_ror:4 row_mask:0xf bank_mask:0xf
v_add_f32_dpp v148, v148, v148 row_ror:4 row_mask:0xf bank_mask:0xf
v_add_f32_dpp v149, v149, v149 row_ror:4 row_mask:0xf bank_mask:0xf
v_add_f32_dpp v150, v150, v150 row_ror:4 row_mask:0xf bank_mask:0xf
v_add_f32_dpp v151, v151, v151 row_ror:4 row_mask:0xf bank_mask:0xf
v_add_f32_dpp v152, v152, v152 row_ror:4 row_mask:0xf bank_mask:0xf
v_add_f32_dpp v153, v153, v153 row_ror:4 row_mask:0xf bank_mask:0xf
v_add_f32_dpp v154, v154, v154 row_ror:4 row_mask:0xf bank_mask:0xf
v_add_f32_dpp v155, v155, v155 row_ror:4 row_mask:0xf bank_mask:0xf
v_add_f32_dpp v156, v156, v156 row_ror:4 row_mask:0xf bank_mask:0xf
v_add_f32_dpp v157, v157, v157 row_ror:4 row_mask:0xf bank_mask:0xf
v_add_f32_dpp v158, v158, v158 row_ror:4 row_mask:0xf bank_mask:0xf
v_add_f32_dpp v159, v159, v159 row_ror:4 row_mask:0xf bank_mask:0xf
v_add_f32_dpp v160, v160, v160 row_ror:4 row_mask:0xf bank_mask:0xf
v_add_f32_dpp v161, v161, v161 row_ror:4 row_mask:0xf bank_mask:0xf
v_add_f32_dpp v162, v162, v162 row_ror:4 row_mask:0xf bank_mask:0xf
v_add_f32_dpp v163, v163, v163 row_ror:4 row_mask:0xf bank_mask:0xf
v_add_f32_dpp v144, v144, v144 row_ror:2 row_mask:0xf bank_mask:0xf
v_add_f32_dpp v145, v145, v145 row_ror:2 row_mask:0xf bank_mask:0xf
v_add_f32_dpp v146, v146, v146 row_ror:2 row_mask:0xf bank_mask:0xf
v_add_f32_dpp v147, v147, v147 row_ror:2 row_mask:0xf bank_mask:0xf
v_add_f32_dpp v148, v148, v148 row_ror:2 row_mask:0xf bank_mask:0xf
v_add_f32_dpp v149, v149, v149 row_ror:2 row_mask:0xf bank_mask:0xf
v_add_f32_dpp v150, v150, v150 row_ror:2 row_mask:0xf bank_mask:0xf
v_add_f32_dpp v151, v151, v151 row_ror:2 row_mask:0xf bank_mask:0xf
v_add_f32_dpp v152, v152, v152 row_ror:2 row_mask:0xf bank_mask:0xf
v_add_f32_dpp v153, v153, v153 row_ror:2 row_mask:0xf bank_mask:0xf
v_add_f32_dpp v154, v154, v154 row_ror:2 row_mask:0xf bank_mask:0xf
v_add_f32_dpp v155, v155, v155 row_ror:2 row_mask:0xf bank_mask:0xf
v_add_f32_dpp v156, v156, v156 row_ror:2 row_mask:0xf bank_mask:0xf
v_add_f32_dpp v157, v157, v157 row_ror:2 row_mask:0xf bank_mask:0xf
v_add_f32_dpp v158, v158, v158 row_ror:2 row_mask:0xf bank_mask:0xf
v_add_f32_dpp v159, v159, v159 row_ror:2 row_mask:0xf bank_mask:0xf
v_add_f32_dpp v160, v160, v160 row_ror:2 row_mask:0xf bank_mask:0xf
v_add_f32_dpp v161, v161, v161 row_ror:2 row_mask:0xf bank_mask:0xf
v_add_f32_dpp v162, v162, v162 row_ror:2 row_mask:0xf bank_mask:0xf
v_add_f32_dpp v163, v163, v163 row_ror:2 row_mask:0xf bank_mask:0xf
v_add_f32_dpp v144, v144, v144 row_ror:1 row_mask:0xf bank_mask:0xf
v_add_f32_dpp v145, v145, v145 row_ror:1 row_mask:0xf bank_mask:0xf
v_add_f32_dpp v146, v146, v146 row_ror:1 row_mask:0xf bank_mask:0xf
v_add_f32_dpp v147, v147, v147 row_ror:1 row_mask:0xf bank_mask:0xf
v_add_f32_dpp v148, v148, v148 row_ror:1 row_mask:0xf bank_mask:0xf
v_add_f32_dpp v149, v149, v149 row_ror:1 row_mask:0xf bank_mask:0xf
v_add_f32_dpp v150, v150, v150 row_ror:1 row_mask:0xf bank_mask:0xf
v_add_f32_dpp v151, v151, v151 row_ror:1 row_mask:0xf bank_mask:0xf
v_add_f32_dpp v152, v152, v152 row_ror:1 row_mask:0xf bank_mask:0xf
v_add_f32_dpp v153, v153, v153 row_ror:1 row_mask:0xf bank_mask:0xf
v_add_f32_dpp v154, v154, v154 row_ror:1 row_mask:0xf bank_mask:0xf
v_add_f32_dpp v155, v155, v155 row_ror:1 row_mask:0xf bank_mask:0xf
v_add_f32_dpp v156, v156, v156 row_ror:1 row_mask:0xf bank_mask:0xf
v_add_f32_dpp v157, v157, v157 row_ror:1 row_mask:0xf bank_mask:0xf
v_add_f32_dpp v158, v158, v158 row_ror:1 row_mask:0xf bank_mask:0xf
v_add_f32_dpp v159, v159, v159 row_ror:1 row_mask:0xf bank_mask:0xf
v_add_f32_dpp v160, v160, v160 row_ror:1 row_mask:0xf bank_mask:0xf
v_add_f32_dpp v161, v161, v161 row_ror:1 row_mask:0xf bank_mask:0xf
v_add_f32_dpp v162, v162, v162 row_ror:1 row_mask:0xf bank_mask:0xf
v_add_f32_dpp v163, v163, v163 row_ror:1 row_mask:0xf bank_mask:0xf
v_pk_mul_f32 v[144:145], v[144:145], v[192:193]
v_pk_mul_f32 v[146:147], v[146:147], v[194:195]
v_pk_mul_f32 v[148:149], v[148:149], v[196:197]
v_pk_mul_f32 v[150:151], v[150:151], v[198:199]
v_pk_mul_f32 v[152:153], v[152:153], v[200:201]
v_pk_mul_f32 v[154:155], v[154:155], v[202:203]
v_pk_mul_f32 v[156:157], v[156:157], v[204:205]
v_pk_mul_f32 v[158:159], v[158:159], v[206:207]
v_pk_mul_f32 v[160:161], v[160:161], v[208:209]
v_pk_mul_f32 v[162:163], v[162:163], v[210:211]
v_cvt_pk_bf16_f32 v164, v144, v145
v_cvt_pk_bf16_f32 v165, v146, v147
v_cvt_pk_bf16_f32 v166, v148, v149
v_cvt_pk_bf16_f32 v167, v150, v151
v_cvt_pk_bf16_f32 v168, v152, v153
v_cvt_pk_bf16_f32 v169, v154, v155
v_cvt_pk_bf16_f32 v170, v156, v157
v_cvt_pk_bf16_f32 v171, v158, v159
v_cvt_pk_bf16_f32 v172, v160, v161
v_cvt_pk_bf16_f32 v173, v162, v163
v_mfma_f32_16x16x32_bf16 v[176:179], v[164:167], v[120:123], v[176:179]
v_mfma_f32_16x16x32_bf16 v[180:183], v[164:167], v[132:135], v[180:183]
v_mfma_f32_16x16x32_bf16 v[176:179], v[168:171], v[124:127], v[176:179]
v_mfma_f32_16x16x32_bf16 v[180:183], v[168:171], v[136:139], v[180:183]
v_mfma_f32_16x16x32_bf16 v[176:179], v[172:175], v[128:131], v[176:179]
v_mfma_f32_16x16x32_bf16 v[180:183], v[172:175], v[140:143], v[180:183]
s_nop 6
v_rcp_f32 v176, v176
v_rcp_f32 v177, v177
v_rcp_f32 v178, v178
v_rcp_f32 v179, v179
v_rcp_f32 v180, v180
v_rcp_f32 v181, v181
v_rcp_f32 v182, v182
v_rcp_f32 v183, v183
v_cndmask_b32 v184, v177, v176, s[54:55]
v_cndmask_b32 v185, v178, v177, s[54:55]
v_cndmask_b32 v186, v179, v178, s[56:57]
v_cndmask_b32 v187, v179, v178, s[54:55]
v_cndmask_b32 v188, v181, v180, s[54:55]
v_cndmask_b32 v189, v182, v181, s[54:55]
v_cndmask_b32 v190, v183, v182, s[56:57]
v_cndmask_b32 v191, v183, v182, s[54:55]
v_mul_f32 v64, v64, v176
v_mul_f32 v65, v65, v176
v_mul_f32 v66, v66, v176
v_mul_f32 v67, v67, v176
v_cvt_pk_bf16_f32 v120, v64, v65
v_cvt_pk_bf16_f32 v121, v66, v67
v_mul_f32 v72, v72, v184
v_mul_f32 v73, v73, v184
v_mul_f32 v74, v74, v177
v_mul_f32 v75, v75, v177
v_cvt_pk_bf16_f32 v122, v72, v73
v_cvt_pk_bf16_f32 v123, v74, v75
s_add_u32 s52, s49, 0
buffer_store_dwordx4 v[120:123], v2, s[64:67], s52 offen sc1
v_mul_f32 v80, v80, v185
v_mul_f32 v81, v81, v185
v_mul_f32 v82, v82, v185
v_mul_f32 v83, v83, v185
v_cvt_pk_bf16_f32 v124, v80, v81
v_cvt_pk_bf16_f32 v125, v82, v83
v_mul_f32 v88, v88, v186
v_mul_f32 v89, v89, v186
v_mul_f32 v90, v90, v187
v_mul_f32 v91, v91, v187
v_cvt_pk_bf16_f32 v126, v88, v89
v_cvt_pk_bf16_f32 v127, v90, v91
s_add_u32 s52, s49, 1024
buffer_store_dwordx4 v[124:127], v2, s[64:67], s52 offen sc1
v_mul_f32 v96, v96, v179
v_mul_f32 v97, v97, v179
v_mul_f32 v98, v98, v179
v_mul_f32 v99, v99, v179
v_cvt_pk_bf16_f32 v128, v96, v97
v_cvt_pk_bf16_f32 v129, v98, v99
s_add_u32 s52, s53, 0
s_mov_b64 exec, s[56:57]
buffer_store_dwordx2 v[128:129], v2, s[64:67], s52 offen sc1
s_mov_b64 exec, -1
v_mul_f32 v68, v68, v180
v_mul_f32 v69, v69, v180
v_mul_f32 v70, v70, v180
v_mul_f32 v71, v71, v180
v_cvt_pk_bf16_f32 v132, v68, v69
v_cvt_pk_bf16_f32 v133, v70, v71
v_mul_f32 v76, v76, v188
v_mul_f32 v77, v77, v188
v_mul_f32 v78, v78, v181
v_mul_f32 v79, v79, v181
v_cvt_pk_bf16_f32 v134, v76, v77
v_cvt_pk_bf16_f32 v135, v78, v79
s_add_u32 s52, s49, 18432
buffer_store_dwordx4 v[132:135], v2, s[64:67], s52 offen sc1
v_mul_f32 v84, v84, v189
v_mul_f32 v85, v85, v189
v_mul_f32 v86, v86, v189
v_mul_f32 v87, v87, v189
v_cvt_pk_bf16_f32 v136, v84, v85
v_cvt_pk_bf16_f32 v137, v86, v87
v_mul_f32 v92, v92, v190
v_mul_f32 v93, v93, v190
v_mul_f32 v94, v94, v191
v_mul_f32 v95, v95, v191
v_cvt_pk_bf16_f32 v138, v92, v93
v_cvt_pk_bf16_f32 v139, v94, v95
s_add_u32 s52, s49, 19456
buffer_store_dwordx4 v[136:139], v2, s[64:67], s52 offen sc1
v_mul_f32 v100, v100, v183
v_mul_f32 v101, v101, v183
v_mul_f32 v102, v102, v183
v_mul_f32 v103, v103, v183
v_cvt_pk_bf16_f32 v140, v100, v101
v_cvt_pk_bf16_f32 v141, v102, v103
s_add_u32 s52, s53, 18432
s_mov_b64 exec, s[56:57]
buffer_store_dwordx2 v[140:141], v2, s[64:67], s52 offen sc1
s_mov_b64 exec, -1
s_waitcnt vmcnt(0)
s_barrier
s_cmp_eq_u32 s28, 0
s_cbranch_scc0 Lpub_34
s_lshl_b32 s68, s29, 2
s_add_u32 s68, s68, s30
s_add_u32 s68, s68, 192
s_lshl_b32 s68, s68, 7
s_add_u32 s68, s68, 10166272
v_mov_b32 v240, 0
v_mov_b32 v241, s70
s_mov_b64 s[74:75], exec
s_mov_b64 exec, 1
buffer_store_dword v241, v240, s[64:67], s68 offen sc1
s_mov_b64 exec, s[74:75]
Lpub_34:
s_sub_u32 s59, s72, 8
s_branch concat_heads__linear_attn_block__ssm_conv_h3__prompt_kernel_out
concat_heads__linear_attn_block__ssm_conv_h3__prompt_kernel_b:
s_sub_u32 s73, s72, 24
s_lshl_b32 s73, s73, 3
s_add_u32 s73, s73, s71
s_waitcnt lgkmcnt(0)
s_mov_b32 s64, s26
s_mov_b32 s65, s27
s_mov_b32 s66, 0x9d2000
s_mov_b32 s67, 0x20000
s_lshl_b32 s41, s28, 6
s_add_u32 s41, s41, s73
s_cmp_ge_u32 s41, 288
s_cbranch_scc1 concat_heads__linear_attn_block__ssm_conv_h3__prompt_kernel_b1skip
s_and_b32 s29, s41, 31
s_lshr_b32 s30, s41, 5
v_and_b32 v2, 7, v0
v_lshrrev_b32 v3, 3, v0
s_lshl_b32 s41, s29, 6
v_lshlrev_b32 v4, 3, v3
v_add_u32 v4, s41, v4
v_mul_u32_u24 v4, 1152, v4
v_lshlrev_b32 v5, 4, v2
v_add_u32 v4, v4, v5
s_lshl_b32 s41, s30, 7
v_add_u32 v4, s41, v4
v_subrev_u32 v6, 3456, v4
s_lshl_b32 s41, s30, 9
v_lshlrev_b32 v7, 6, v2
v_add_u32 v7, s41, v7
s_mov_b32 s32, s12
s_mov_b32 s33, s13
s_mov_b32 s34, 0x240000
s_mov_b32 s35, 0x20000
v_add_u32 v8, 0, v6
buffer_load_dwordx4 v[64:67], v8, s[32:35], 0 offen nt
v_add_u32 v8, 1152, v6
buffer_load_dwordx4 v[68:71], v8, s[32:35], 0 offen nt
v_add_u32 v8, 2304, v6
buffer_load_dwordx4 v[72:75], v8, s[32:35], 0 offen nt
s_movk_i32 s41, 0
buffer_load_dwordx4 v[76:79], v4, s[32:35], s41 offen nt
s_movk_i32 s41, 1152
buffer_load_dwordx4 v[80:83], v4, s[32:35], s41 offen nt
s_movk_i32 s41, 2304
buffer_load_dwordx4 v[84:87], v4, s[32:35], s41 offen nt
s_movk_i32 s41, 3456
buffer_load_dwordx4 v[88:91], v4, s[32:35], s41 offen nt
s_movk_i32 s41, 4608
buffer_load_dwordx4 v[92:95], v4, s[32:35], s41 offen nt
s_movk_i32 s41, 5760
buffer_load_dwordx4 v[96:99], v4, s[32:35], s41 offen nt
s_movk_i32 s41, 6912
buffer_load_dwordx4 v[100:103], v4, s[32:35], s41 offen nt
s_movk_i32 s41, 8064
buffer_load_dwordx4 v[104:107], v4, s[32:35], s41 offen nt
s_mov_b32 s52, s16
s_mov_b32 s53, s17
s_mov_b32 s54, 0x1200
s_mov_b32 s55, 0x20000
buffer_load_dwordx4 v[140:143], v7, s[52:55], 0 offen offset:0
buffer_load_dwordx4 v[144:147], v7, s[52:55], 0 offen offset:16
buffer_load_dwordx4 v[148:151], v7, s[52:55], 0 offen offset:32
buffer_load_dwordx4 v[152:155], v7, s[52:55], 0 offen offset:48
s_mov_b32 s36, s14
s_mov_b32 s37, s15
s_mov_b32 s38, 0x240000
s_mov_b32 s39, 0x20000
s_movk_i32 s41, 0
buffer_load_dwordx4 v[108:111], v4, s[36:39], s41 offen nt
s_movk_i32 s41, 1152
buffer_load_dwordx4 v[112:115], v4, s[36:39], s41 offen nt
s_movk_i32 s41, 2304
buffer_load_dwordx4 v[116:119], v4, s[36:39], s41 offen nt
s_movk_i32 s41, 3456
buffer_load_dwordx4 v[120:123], v4, s[36:39], s41 offen nt
s_movk_i32 s41, 4608
buffer_load_dwordx4 v[124:127], v4, s[36:39], s41 offen nt
s_movk_i32 s41, 5760
buffer_load_dwordx4 v[128:131], v4, s[36:39], s41 offen nt
s_movk_i32 s41, 6912
buffer_load_dwordx4 v[132:135], v4, s[36:39], s41 offen nt
s_movk_i32 s41, 8064
buffer_load_dwordx4 v[136:139], v4, s[36:39], s41 offen nt
s_mov_b32 s60, s24
s_mov_b32 s61, s25
s_mov_b32 s62, 0x100
s_mov_b32 s63, 0x20000
v_mov_b32 v240, 0
buffer_load_dword v239, v240, s[60:63], 0 offen sc1
s_mov_b32 s44, 0xffff0000
v_xor_b32 v9, v2, v3
v_lshlrev_b32 v9, 4, v9
v_lshl_add_u32 v9, v3, 7, v9
s_lshl_b32 s45, s28, 13
v_add_u32 v9, s45, v9
v_lshlrev_b32 v10, 10, v3
v_lshl_add_u32 v10, v2, 7, v10
v_add_u32 v10, s45, v10
v_lshlrev_b32 v11, 12, v3
v_lshl_add_u32 v11, v2, 4, v11
s_lshl_b32 s41, s30, 18
s_lshl_b32 s42, s29, 7
s_add_u32 s41, s41, s42
s_add_u32 s46, s41, 0
s_waitcnt vmcnt(9)
v_lshlrev_b32 v160, 16, v140
v_lshlrev_b32 v161, 16, v142
v_and_b32 v162, s44, v140
v_and_b32 v163, s44, v142
v_lshlrev_b32 v164, 16, v141
v_lshlrev_b32 v165, 16, v143
v_and_b32 v166, s44, v141
v_and_b32 v167, s44, v143
v_lshlrev_b32 v168, 16, v64
v_and_b32 v169, s44, v64
v_lshlrev_b32 v170, 16, v68
v_and_b32 v171, s44, v68
v_lshlrev_b32 v172, 16, v72
v_and_b32 v173, s44, v72
v_lshlrev_b32 v174, 16, v76
v_and_b32 v175, s44, v76
v_lshlrev_b32 v176, 16, v80
v_and_b32 v177, s44, v80
v_lshlrev_b32 v178, 16, v84
v_and_b32 v179, s44, v84
v_lshlrev_b32 v180, 16, v88
v_and_b32 v181, s44, v88
v_lshlrev_b32 v182, 16, v92
v_and_b32 v183, s44, v92
v_lshlrev_b32 v184, 16, v96
v_and_b32 v185, s44, v96
v_lshlrev_b32 v186, 16, v100
v_and_b32 v187, s44, v100
v_lshlrev_b32 v188, 16, v104
v_and_b32 v189, s44, v104
v_pk_mul_f32 v[190:191], v[168:169], v[166:167]
v_pk_mul_f32 v[192:193], v[170:171], v[166:167]
v_pk_mul_f32 v[194:195], v[172:173], v[166:167]
v_pk_mul_f32 v[196:197], v[174:175], v[166:167]
v_pk_mul_f32 v[198:199], v[176:177], v[166:167]
v_pk_mul_f32 v[200:201], v[178:179], v[166:167]
v_pk_mul_f32 v[202:203], v[180:181], v[166:167]
v_pk_mul_f32 v[204:205], v[182:183], v[166:167]
v_pk_fma_f32 v[190:191], v[170:171], v[164:165], v[190:191]
v_pk_fma_f32 v[192:193], v[172:173], v[164:165], v[192:193]
v_pk_fma_f32 v[194:195], v[174:175], v[164:165], v[194:195]
v_pk_fma_f32 v[196:197], v[176:177], v[164:165], v[196:197]
v_pk_fma_f32 v[198:199], v[178:179], v[164:165], v[198:199]
v_pk_fma_f32 v[200:201], v[180:181], v[164:165], v[200:201]
v_pk_fma_f32 v[202:203], v[182:183], v[164:165], v[202:203]
v_pk_fma_f32 v[204:205], v[184:185], v[164:165], v[204:205]
v_pk_fma_f32 v[190:191], v[172:173], v[162:163], v[190:191]
v_pk_fma_f32 v[192:193], v[174:175], v[162:163], v[192:193]
v_pk_fma_f32 v[194:195], v[176:177], v[162:163], v[194:195]
v_pk_fma_f32 v[196:197], v[178:179], v[162:163], v[196:197]
v_pk_fma_f32 v[198:199], v[180:181], v[162:163], v[198:199]
v_pk_fma_f32 v[200:201], v[182:183], v[162:163], v[200:201]
v_pk_fma_f32 v[202:203], v[184:185], v[162:163], v[202:203]
v_pk_fma_f32 v[204:205], v[186:187], v[162:163], v[204:205]
v_pk_fma_f32 v[190:191], v[174:175], v[160:161], v[190:191]
v_pk_fma_f32 v[192:193], v[176:177], v[160:161], v[192:193]
v_pk_fma_f32 v[194:195], v[178:179], v[160:161], v[194:195]
v_pk_fma_f32 v[196:197], v[180:181], v[160:161], v[196:197]
v_pk_fma_f32 v[198:199], v[182:183], v[160:161], v[198:199]
v_pk_fma_f32 v[200:201], v[184:185], v[160:161], v[200:201]
v_pk_fma_f32 v[202:203], v[186:187], v[160:161], v[202:203]
v_pk_fma_f32 v[204:205], v[188:189], v[160:161], v[204:205]
s_waitcnt vmcnt(1)
v_lshlrev_b32 v168, 16, v108
v_and_b32 v169, s44, v108
v_lshlrev_b32 v170, 16, v112
v_and_b32 v171, s44, v112
v_lshlrev_b32 v172, 16, v116
v_and_b32 v173, s44, v116
v_lshlrev_b32 v174, 16, v120
v_and_b32 v175, s44, v120
v_lshlrev_b32 v176, 16, v124
v_and_b32 v177, s44, v124
v_lshlrev_b32 v178, 16, v128
v_and_b32 v179, s44, v128
v_lshlrev_b32 v180, 16, v132
v_and_b32 v181, s44, v132
v_lshlrev_b32 v182, 16, v136
v_and_b32 v183, s44, v136
v_pk_mul_f32 v[190:191], v[190:191], v[168:169]
v_pk_mul_f32 v[192:193], v[192:193], v[170:171]
v_pk_mul_f32 v[194:195], v[194:195], v[172:173]
v_pk_mul_f32 v[196:197], v[196:197], v[174:175]
v_pk_mul_f32 v[198:199], v[198:199], v[176:177]
v_pk_mul_f32 v[200:201], v[200:201], v[178:179]
v_pk_mul_f32 v[202:203], v[202:203], v[180:181]
v_pk_mul_f32 v[204:205], v[204:205], v[182:183]
v_cvt_pk_bf16_f32 v206, v190, v192
v_cvt_pk_bf16_f32 v207, v194, v196
v_cvt_pk_bf16_f32 v208, v198, v200
v_cvt_pk_bf16_f32 v209, v202, v204
ds_write_b128 v9, v[206:209] offset:0
v_cvt_pk_bf16_f32 v210, v191, v193
v_cvt_pk_bf16_f32 v211, v195, v197
v_cvt_pk_bf16_f32 v212, v199, v201
v_cvt_pk_bf16_f32 v213, v203, v205
ds_write_b128 v9, v[210:213] offset:1024
v_lshlrev_b32 v160, 16, v144
v_lshlrev_b32 v161, 16, v146
v_and_b32 v162, s44, v144
v_and_b32 v163, s44, v146
v_lshlrev_b32 v164, 16, v145
v_lshlrev_b32 v165, 16, v147
v_and_b32 v166, s44, v145
v_and_b32 v167, s44, v147
v_lshlrev_b32 v168, 16, v65
v_and_b32 v169, s44, v65
v_lshlrev_b32 v170, 16, v69
v_and_b32 v171, s44, v69
v_lshlrev_b32 v172, 16, v73
v_and_b32 v173, s44, v73
v_lshlrev_b32 v174, 16, v77
v_and_b32 v175, s44, v77
v_lshlrev_b32 v176, 16, v81
v_and_b32 v177, s44, v81
v_lshlrev_b32 v178, 16, v85
v_and_b32 v179, s44, v85
v_lshlrev_b32 v180, 16, v89
v_and_b32 v181, s44, v89
v_lshlrev_b32 v182, 16, v93
v_and_b32 v183, s44, v93
v_lshlrev_b32 v184, 16, v97
v_and_b32 v185, s44, v97
v_lshlrev_b32 v186, 16, v101
v_and_b32 v187, s44, v101
v_lshlrev_b32 v188, 16, v105
v_and_b32 v189, s44, v105
v_pk_mul_f32 v[190:191], v[168:169], v[166:167]
v_pk_mul_f32 v[192:193], v[170:171], v[166:167]
v_pk_mul_f32 v[194:195], v[172:173], v[166:167]
v_pk_mul_f32 v[196:197], v[174:175], v[166:167]
v_pk_mul_f32 v[198:199], v[176:177], v[166:167]
v_pk_mul_f32 v[200:201], v[178:179], v[166:167]
v_pk_mul_f32 v[202:203], v[180:181], v[166:167]
v_pk_mul_f32 v[204:205], v[182:183], v[166:167]
v_pk_fma_f32 v[190:191], v[170:171], v[164:165], v[190:191]
v_pk_fma_f32 v[192:193], v[172:173], v[164:165], v[192:193]
v_pk_fma_f32 v[194:195], v[174:175], v[164:165], v[194:195]
v_pk_fma_f32 v[196:197], v[176:177], v[164:165], v[196:197]
v_pk_fma_f32 v[198:199], v[178:179], v[164:165], v[198:199]
v_pk_fma_f32 v[200:201], v[180:181], v[164:165], v[200:201]
v_pk_fma_f32 v[202:203], v[182:183], v[164:165], v[202:203]
v_pk_fma_f32 v[204:205], v[184:185], v[164:165], v[204:205]
v_pk_fma_f32 v[190:191], v[172:173], v[162:163], v[190:191]
v_pk_fma_f32 v[192:193], v[174:175], v[162:163], v[192:193]
v_pk_fma_f32 v[194:195], v[176:177], v[162:163], v[194:195]
v_pk_fma_f32 v[196:197], v[178:179], v[162:163], v[196:197]
v_pk_fma_f32 v[198:199], v[180:181], v[162:163], v[198:199]
v_pk_fma_f32 v[200:201], v[182:183], v[162:163], v[200:201]
v_pk_fma_f32 v[202:203], v[184:185], v[162:163], v[202:203]
v_pk_fma_f32 v[204:205], v[186:187], v[162:163], v[204:205]
v_pk_fma_f32 v[190:191], v[174:175], v[160:161], v[190:191]
v_pk_fma_f32 v[192:193], v[176:177], v[160:161], v[192:193]
v_pk_fma_f32 v[194:195], v[178:179], v[160:161], v[194:195]
v_pk_fma_f32 v[196:197], v[180:181], v[160:161], v[196:197]
v_pk_fma_f32 v[198:199], v[182:183], v[160:161], v[198:199]
v_pk_fma_f32 v[200:201], v[184:185], v[160:161], v[200:201]
v_pk_fma_f32 v[202:203], v[186:187], v[160:161], v[202:203]
v_pk_fma_f32 v[204:205], v[188:189], v[160:161], v[204:205]
v_lshlrev_b32 v168, 16, v109
v_and_b32 v169, s44, v109
v_lshlrev_b32 v170, 16, v113
v_and_b32 v171, s44, v113
v_lshlrev_b32 v172, 16, v117
v_and_b32 v173, s44, v117
v_lshlrev_b32 v174, 16, v121
v_and_b32 v175, s44, v121
v_lshlrev_b32 v176, 16, v125
v_and_b32 v177, s44, v125
v_lshlrev_b32 v178, 16, v129
v_and_b32 v179, s44, v129
v_lshlrev_b32 v180, 16, v133
v_and_b32 v181, s44, v133
v_lshlrev_b32 v182, 16, v137
v_and_b32 v183, s44, v137
v_pk_mul_f32 v[190:191], v[190:191], v[168:169]
v_pk_mul_f32 v[192:193], v[192:193], v[170:171]
v_pk_mul_f32 v[194:195], v[194:195], v[172:173]
v_pk_mul_f32 v[196:197], v[196:197], v[174:175]
v_pk_mul_f32 v[198:199], v[198:199], v[176:177]
v_pk_mul_f32 v[200:201], v[200:201], v[178:179]
v_pk_mul_f32 v[202:203], v[202:203], v[180:181]
v_pk_mul_f32 v[204:205], v[204:205], v[182:183]
v_cvt_pk_bf16_f32 v206, v190, v192
v_cvt_pk_bf16_f32 v207, v194, v196
v_cvt_pk_bf16_f32 v208, v198, v200
v_cvt_pk_bf16_f32 v209, v202, v204
ds_write_b128 v9, v[206:209] offset:2048
v_cvt_pk_bf16_f32 v210, v191, v193
v_cvt_pk_bf16_f32 v211, v195, v197
v_cvt_pk_bf16_f32 v212, v199, v201
v_cvt_pk_bf16_f32 v213, v203, v205
ds_write_b128 v9, v[210:213] offset:3072
v_lshlrev_b32 v160, 16, v148
v_lshlrev_b32 v161, 16, v150
v_and_b32 v162, s44, v148
v_and_b32 v163, s44, v150
v_lshlrev_b32 v164, 16, v149
v_lshlrev_b32 v165, 16, v151
v_and_b32 v166, s44, v149
v_and_b32 v167, s44, v151
v_lshlrev_b32 v168, 16, v66
v_and_b32 v169, s44, v66
v_lshlrev_b32 v170, 16, v70
v_and_b32 v171, s44, v70
v_lshlrev_b32 v172, 16, v74
v_and_b32 v173, s44, v74
v_lshlrev_b32 v174, 16, v78
v_and_b32 v175, s44, v78
v_lshlrev_b32 v176, 16, v82
v_and_b32 v177, s44, v82
v_lshlrev_b32 v178, 16, v86
v_and_b32 v179, s44, v86
v_lshlrev_b32 v180, 16, v90
v_and_b32 v181, s44, v90
v_lshlrev_b32 v182, 16, v94
v_and_b32 v183, s44, v94
v_lshlrev_b32 v184, 16, v98
v_and_b32 v185, s44, v98
v_lshlrev_b32 v186, 16, v102
v_and_b32 v187, s44, v102
v_lshlrev_b32 v188, 16, v106
v_and_b32 v189, s44, v106
v_pk_mul_f32 v[190:191], v[168:169], v[166:167]
v_pk_mul_f32 v[192:193], v[170:171], v[166:167]
v_pk_mul_f32 v[194:195], v[172:173], v[166:167]
v_pk_mul_f32 v[196:197], v[174:175], v[166:167]
v_pk_mul_f32 v[198:199], v[176:177], v[166:167]
v_pk_mul_f32 v[200:201], v[178:179], v[166:167]
v_pk_mul_f32 v[202:203], v[180:181], v[166:167]
v_pk_mul_f32 v[204:205], v[182:183], v[166:167]
v_pk_fma_f32 v[190:191], v[170:171], v[164:165], v[190:191]
v_pk_fma_f32 v[192:193], v[172:173], v[164:165], v[192:193]
v_pk_fma_f32 v[194:195], v[174:175], v[164:165], v[194:195]
v_pk_fma_f32 v[196:197], v[176:177], v[164:165], v[196:197]
v_pk_fma_f32 v[198:199], v[178:179], v[164:165], v[198:199]
v_pk_fma_f32 v[200:201], v[180:181], v[164:165], v[200:201]
v_pk_fma_f32 v[202:203], v[182:183], v[164:165], v[202:203]
v_pk_fma_f32 v[204:205], v[184:185], v[164:165], v[204:205]
v_pk_fma_f32 v[190:191], v[172:173], v[162:163], v[190:191]
v_pk_fma_f32 v[192:193], v[174:175], v[162:163], v[192:193]
v_pk_fma_f32 v[194:195], v[176:177], v[162:163], v[194:195]
v_pk_fma_f32 v[196:197], v[178:179], v[162:163], v[196:197]
v_pk_fma_f32 v[198:199], v[180:181], v[162:163], v[198:199]
v_pk_fma_f32 v[200:201], v[182:183], v[162:163], v[200:201]
v_pk_fma_f32 v[202:203], v[184:185], v[162:163], v[202:203]
v_pk_fma_f32 v[204:205], v[186:187], v[162:163], v[204:205]
v_pk_fma_f32 v[190:191], v[174:175], v[160:161], v[190:191]
v_pk_fma_f32 v[192:193], v[176:177], v[160:161], v[192:193]
v_pk_fma_f32 v[194:195], v[178:179], v[160:161], v[194:195]
v_pk_fma_f32 v[196:197], v[180:181], v[160:161], v[196:197]
v_pk_fma_f32 v[198:199], v[182:183], v[160:161], v[198:199]
v_pk_fma_f32 v[200:201], v[184:185], v[160:161], v[200:201]
v_pk_fma_f32 v[202:203], v[186:187], v[160:161], v[202:203]
v_pk_fma_f32 v[204:205], v[188:189], v[160:161], v[204:205]
v_lshlrev_b32 v168, 16, v110
v_and_b32 v169, s44, v110
v_lshlrev_b32 v170, 16, v114
v_and_b32 v171, s44, v114
v_lshlrev_b32 v172, 16, v118
v_and_b32 v173, s44, v118
v_lshlrev_b32 v174, 16, v122
v_and_b32 v175, s44, v122
v_lshlrev_b32 v176, 16, v126
v_and_b32 v177, s44, v126
v_lshlrev_b32 v178, 16, v130
v_and_b32 v179, s44, v130
v_lshlrev_b32 v180, 16, v134
v_and_b32 v181, s44, v134
v_lshlrev_b32 v182, 16, v138
v_and_b32 v183, s44, v138
v_pk_mul_f32 v[190:191], v[190:191], v[168:169]
v_pk_mul_f32 v[192:193], v[192:193], v[170:171]
v_pk_mul_f32 v[194:195], v[194:195], v[172:173]
v_pk_mul_f32 v[196:197], v[196:197], v[174:175]
v_pk_mul_f32 v[198:199], v[198:199], v[176:177]
v_pk_mul_f32 v[200:201], v[200:201], v[178:179]
v_pk_mul_f32 v[202:203], v[202:203], v[180:181]
v_pk_mul_f32 v[204:205], v[204:205], v[182:183]
v_cvt_pk_bf16_f32 v206, v190, v192
v_cvt_pk_bf16_f32 v207, v194, v196
v_cvt_pk_bf16_f32 v208, v198, v200
v_cvt_pk_bf16_f32 v209, v202, v204
ds_write_b128 v9, v[206:209] offset:4096
v_cvt_pk_bf16_f32 v210, v191, v193
v_cvt_pk_bf16_f32 v211, v195, v197
v_cvt_pk_bf16_f32 v212, v199, v201
v_cvt_pk_bf16_f32 v213, v203, v205
ds_write_b128 v9, v[210:213] offset:5120
v_lshlrev_b32 v160, 16, v152
v_lshlrev_b32 v161, 16, v154
v_and_b32 v162, s44, v152
v_and_b32 v163, s44, v154
v_lshlrev_b32 v164, 16, v153
v_lshlrev_b32 v165, 16, v155
v_and_b32 v166, s44, v153
v_and_b32 v167, s44, v155
v_lshlrev_b32 v168, 16, v67
v_and_b32 v169, s44, v67
v_lshlrev_b32 v170, 16, v71
v_and_b32 v171, s44, v71
v_lshlrev_b32 v172, 16, v75
v_and_b32 v173, s44, v75
v_lshlrev_b32 v174, 16, v79
v_and_b32 v175, s44, v79
v_lshlrev_b32 v176, 16, v83
v_and_b32 v177, s44, v83
v_lshlrev_b32 v178, 16, v87
v_and_b32 v179, s44, v87
v_lshlrev_b32 v180, 16, v91
v_and_b32 v181, s44, v91
v_lshlrev_b32 v182, 16, v95
v_and_b32 v183, s44, v95
v_lshlrev_b32 v184, 16, v99
v_and_b32 v185, s44, v99
v_lshlrev_b32 v186, 16, v103
v_and_b32 v187, s44, v103
v_lshlrev_b32 v188, 16, v107
v_and_b32 v189, s44, v107
v_pk_mul_f32 v[190:191], v[168:169], v[166:167]
v_pk_mul_f32 v[192:193], v[170:171], v[166:167]
v_pk_mul_f32 v[194:195], v[172:173], v[166:167]
v_pk_mul_f32 v[196:197], v[174:175], v[166:167]
v_pk_mul_f32 v[198:199], v[176:177], v[166:167]
v_pk_mul_f32 v[200:201], v[178:179], v[166:167]
v_pk_mul_f32 v[202:203], v[180:181], v[166:167]
v_pk_mul_f32 v[204:205], v[182:183], v[166:167]
v_pk_fma_f32 v[190:191], v[170:171], v[164:165], v[190:191]
v_pk_fma_f32 v[192:193], v[172:173], v[164:165], v[192:193]
v_pk_fma_f32 v[194:195], v[174:175], v[164:165], v[194:195]
v_pk_fma_f32 v[196:197], v[176:177], v[164:165], v[196:197]
v_pk_fma_f32 v[198:199], v[178:179], v[164:165], v[198:199]
v_pk_fma_f32 v[200:201], v[180:181], v[164:165], v[200:201]
v_pk_fma_f32 v[202:203], v[182:183], v[164:165], v[202:203]
v_pk_fma_f32 v[204:205], v[184:185], v[164:165], v[204:205]
v_pk_fma_f32 v[190:191], v[172:173], v[162:163], v[190:191]
v_pk_fma_f32 v[192:193], v[174:175], v[162:163], v[192:193]
v_pk_fma_f32 v[194:195], v[176:177], v[162:163], v[194:195]
v_pk_fma_f32 v[196:197], v[178:179], v[162:163], v[196:197]
v_pk_fma_f32 v[198:199], v[180:181], v[162:163], v[198:199]
v_pk_fma_f32 v[200:201], v[182:183], v[162:163], v[200:201]
v_pk_fma_f32 v[202:203], v[184:185], v[162:163], v[202:203]
v_pk_fma_f32 v[204:205], v[186:187], v[162:163], v[204:205]
v_pk_fma_f32 v[190:191], v[174:175], v[160:161], v[190:191]
v_pk_fma_f32 v[192:193], v[176:177], v[160:161], v[192:193]
v_pk_fma_f32 v[194:195], v[178:179], v[160:161], v[194:195]
v_pk_fma_f32 v[196:197], v[180:181], v[160:161], v[196:197]
v_pk_fma_f32 v[198:199], v[182:183], v[160:161], v[198:199]
v_pk_fma_f32 v[200:201], v[184:185], v[160:161], v[200:201]
v_pk_fma_f32 v[202:203], v[186:187], v[160:161], v[202:203]
v_pk_fma_f32 v[204:205], v[188:189], v[160:161], v[204:205]
v_lshlrev_b32 v168, 16, v111
v_and_b32 v169, s44, v111
v_lshlrev_b32 v170, 16, v115
v_and_b32 v171, s44, v115
v_lshlrev_b32 v172, 16, v119
v_and_b32 v173, s44, v119
v_lshlrev_b32 v174, 16, v123
v_and_b32 v175, s44, v123
v_lshlrev_b32 v176, 16, v127
v_and_b32 v177, s44, v127
v_lshlrev_b32 v178, 16, v131
v_and_b32 v179, s44, v131
v_lshlrev_b32 v180, 16, v135
v_and_b32 v181, s44, v135
v_lshlrev_b32 v182, 16, v139
v_and_b32 v183, s44, v139
v_pk_mul_f32 v[190:191], v[190:191], v[168:169]
v_pk_mul_f32 v[192:193], v[192:193], v[170:171]
v_pk_mul_f32 v[194:195], v[194:195], v[172:173]
v_pk_mul_f32 v[196:197], v[196:197], v[174:175]
v_pk_mul_f32 v[198:199], v[198:199], v[176:177]
v_pk_mul_f32 v[200:201], v[200:201], v[178:179]
v_pk_mul_f32 v[202:203], v[202:203], v[180:181]
v_pk_mul_f32 v[204:205], v[204:205], v[182:183]
v_cvt_pk_bf16_f32 v206, v190, v192
v_cvt_pk_bf16_f32 v207, v194, v196
v_cvt_pk_bf16_f32 v208, v198, v200
v_cvt_pk_bf16_f32 v209, v202, v204
ds_write_b128 v9, v[206:209] offset:6144
v_cvt_pk_bf16_f32 v210, v191, v193
v_cvt_pk_bf16_f32 v211, v195, v197
v_cvt_pk_bf16_f32 v212, v199, v201
v_cvt_pk_bf16_f32 v213, v203, v205
ds_write_b128 v9, v[210:213] offset:7168
s_waitcnt lgkmcnt(0)
v_xor_b32 v12, 0, v2
v_lshl_add_u32 v12, v12, 4, v10
ds_read_b128 v[64:67], v12
v_xor_b32 v12, 1, v2
v_lshl_add_u32 v12, v12, 4, v10
ds_read_b128 v[68:71], v12
v_xor_b32 v12, 2, v2
v_lshl_add_u32 v12, v12, 4, v10
ds_read_b128 v[72:75], v12
v_xor_b32 v12, 3, v2
v_lshl_add_u32 v12, v12, 4, v10
ds_read_b128 v[76:79], v12
v_xor_b32 v12, 4, v2
v_lshl_add_u32 v12, v12, 4, v10
ds_read_b128 v[80:83], v12
v_xor_b32 v12, 5, v2
v_lshl_add_u32 v12, v12, 4, v10
ds_read_b128 v[84:87], v12
v_xor_b32 v12, 6, v2
v_lshl_add_u32 v12, v12, 4, v10
ds_read_b128 v[88:91], v12
v_xor_b32 v12, 7, v2
v_lshl_add_u32 v12, v12, 4, v10
ds_read_b128 v[92:95], v12
s_waitcnt lgkmcnt(7)
s_add_u32 s42, s46, 0
buffer_store_dwordx4 v[64:67], v11, s[64:67], s42 offen sc1
s_waitcnt lgkmcnt(6)
s_add_u32 s42, s46, 32768
buffer_store_dwordx4 v[68:71], v11, s[64:67], s42 offen sc1
s_waitcnt lgkmcnt(5)
s_add_u32 s42, s46, 65536
buffer_store_dwordx4 v[72:75], v11, s[64:67], s42 offen sc1
s_waitcnt lgkmcnt(4)
s_add_u32 s42, s46, 98304
buffer_store_dwordx4 v[76:79], v11, s[64:67], s42 offen sc1
s_waitcnt lgkmcnt(3)
s_add_u32 s42, s46, 131072
buffer_store_dwordx4 v[80:83], v11, s[64:67], s42 offen sc1
s_waitcnt lgkmcnt(2)
s_add_u32 s42, s46, 163840
buffer_store_dwordx4 v[84:87], v11, s[64:67], s42 offen sc1
s_waitcnt lgkmcnt(1)
s_add_u32 s42, s46, 196608
buffer_store_dwordx4 v[88:91], v11, s[64:67], s42 offen sc1
s_waitcnt lgkmcnt(0)
s_add_u32 s42, s46, 229376
buffer_store_dwordx4 v[92:95], v11, s[64:67], s42 offen sc1
s_waitcnt vmcnt(8)
s_branch concat_heads__linear_attn_block__ssm_conv_h3__prompt_kernel_b1join
concat_heads__linear_attn_block__ssm_conv_h3__prompt_kernel_b1skip:
s_mov_b32 s60, s24
s_mov_b32 s61, s25
s_mov_b32 s62, 0x100
s_mov_b32 s63, 0x20000
v_mov_b32 v240, 0
buffer_load_dword v239, v240, s[60:63], 0 offen sc1
s_waitcnt vmcnt(0)
concat_heads__linear_attn_block__ssm_conv_h3__prompt_kernel_b1join:
v_readfirstlane_b32 s70, v239
s_nop 0
s_cmp_lg_u32 s70, 0
s_cbranch_scc1 Ltr_35
s_mov_b32 s60, s24
s_mov_b32 s61, s25
s_mov_b32 s62, 0x100
s_mov_b32 s63, 0x20000
v_mov_b32 v240, 0
buffer_load_dword v239, v240, s[60:63], 0 offen sc1
s_waitcnt vmcnt(0)
v_readfirstlane_b32 s70, v239
s_nop 0
s_cmp_lg_u32 s70, 0
s_cbranch_scc1 Lnf_36
s_mov_b32 s60, s24
s_mov_b32 s61, s25
s_mov_b32 s62, 0x100
s_mov_b32 s63, 0x20000
s_mov_b32 s69, 0
v_mov_b32 v240, 0
Lnq_37:
buffer_load_dword v239, v240, s[60:63], 0 offen sc1
s_add_u32 s69, s69, 1
s_waitcnt vmcnt(0)
v_readfirstlane_b32 s70, v239
s_cmp_ge_u32 s69, 100000
s_cbranch_scc1 Lnf_36
s_cmp_eq_u32 s70, 0
s_cbranch_scc1 Lnq_37
Lnf_36:
Ltr_35:
s_mul_i32 s92, s70, 0x9E3779B1
s_cmp_ge_u32 s73, 36
s_cbranch_scc1 concat_heads__linear_attn_block__ssm_conv_h3__prompt_kernel_nob1
s_waitcnt vmcnt(0)
s_barrier
s_cmp_eq_u32 s28, 0
s_cbranch_scc0 Lpub_38
s_add_u32 s68, s73, 0
s_lshl_b32 s68, s68, 7
s_add_u32 s68, s68, 10166272
v_mov_b32 v240, 0
v_mov_b32 v241, s70
s_mov_b64 s[74:75], exec
s_mov_b64 exec, 1
buffer_store_dword v241, v240, s[64:67], s68 offen sc1
s_mov_b64 exec, s[74:75]
Lpub_38:
s_mov_b32 s29, s73
s_mov_b32 s32, s8
s_mov_b32 s33, s9
s_mov_b32 s34, 0xa2000
s_mov_b32 s35, 0x20000
s_cmp_lt_u32 s29, 32
s_cbranch_scc0 Lw2m_39
s_lshr_b32 s30, s29, 2
s_and_b32 s31, s29, 3
s_max_u32 s41, s31, 1
s_sub_u32 s41, s41, 1
s_lshl_b32 s41, s41, 4
s_mul_i32 s42, s30, 72
s_add_u32 s41, s41, s42
s_mov_b32 s42, 0
s_branch Lw2e_40
Lw2m_39:
s_sub_u32 s30, s29, 32
s_lshl_b32 s30, s30, 1
s_mov_b32 s31, 4
s_mul_i32 s41, s30, 72
s_add_u32 s41, s41, 48
s_mov_b32 s42, 40
Lw2e_40:
s_lshl_b32 s43, s28, 6
s_lshl_b32 s44, s28, 10
v_add_u32 v2, s43, v0
v_mul_u32_u24 v3, 3543, v2
v_lshrrev_b32 v3, 18, v3
v_mul_u32_u24 v4, 74, v3
v_sub_u32 v4, v2, v4
v_min_u32 v4, 71, v4
v_cmp_le_u32 vcc, 32, v3
v_mov_b32 v5, s42
s_nop 0
v_cndmask_b32 v5, 0, v5, vcc
v_add3_u32 v3, v3, v5, s41
v_mul_u32_u24 v3, 1152, v3
v_lshl_add_u32 v3, v4, 4, v3
s_add_u32 m0, s44, 34816
s_nop 0
buffer_load_dwordx4 v3, s[32:35], 0 offen nt lds
v_add_u32 v2, s43, v0
v_add_u32 v2, 512, v2
v_mul_u32_u24 v3, 3543, v2
v_lshrrev_b32 v3, 18, v3
v_mul_u32_u24 v4, 74, v3
v_sub_u32 v4, v2, v4
v_min_u32 v4, 71, v4
v_cmp_le_u32 vcc, 32, v3
v_mov_b32 v5, s42
s_nop 0
v_cndmask_b32 v5, 0, v5, vcc
v_add3_u32 v3, v3, v5, s41
v_mul_u32_u24 v3, 1152, v3
v_lshl_add_u32 v3, v4, 4, v3
s_add_u32 m0, s44, 43008
s_nop 0
buffer_load_dwordx4 v3, s[32:35], 0 offen nt lds
v_add_u32 v2, s43, v0
v_add_u32 v2, 1024, v2
v_mul_u32_u24 v3, 3543, v2
v_lshrrev_b32 v3, 18, v3
v_mul_u32_u24 v4, 74, v3
v_sub_u32 v4, v2, v4
v_min_u32 v4, 71, v4
v_cmp_le_u32 vcc, 32, v3
v_mov_b32 v5, s42
s_nop 0
v_cndmask_b32 v5, 0, v5, vcc
v_add3_u32 v3, v3, v5, s41
v_mul_u32_u24 v3, 1152, v3
v_lshl_add_u32 v3, v4, 4, v3
s_add_u32 m0, s44, 51200
s_nop 0
buffer_load_dwordx4 v3, s[32:35], 0 offen nt lds
v_add_u32 v2, s43, v0
v_add_u32 v2, 1536, v2
v_mul_u32_u24 v3, 3543, v2
v_lshrrev_b32 v3, 18, v3
v_mul_u32_u24 v4, 74, v3
v_sub_u32 v4, v2, v4
v_min_u32 v4, 71, v4
v_cmp_le_u32 vcc, 32, v3
v_mov_b32 v5, s42
s_nop 0
v_cndmask_b32 v5, 0, v5, vcc
v_add3_u32 v3, v3, v5, s41
v_mul_u32_u24 v3, 1152, v3
v_lshl_add_u32 v3, v4, 4, v3
s_add_u32 m0, s44, 59392
s_nop 0
buffer_load_dwordx4 v3, s[32:35], 0 offen nt lds
v_add_u32 v2, s43, v0
v_add_u32 v2, 2048, v2
v_mul_u32_u24 v3, 3543, v2
v_lshrrev_b32 v3, 18, v3
v_mul_u32_u24 v4, 74, v3
v_sub_u32 v4, v2, v4
v_min_u32 v4, 71, v4
v_cmp_le_u32 vcc, 32, v3
v_mov_b32 v5, s42
s_nop 0
v_cndmask_b32 v5, 0, v5, vcc
v_add3_u32 v3, v3, v5, s41
v_mul_u32_u24 v3, 1152, v3
v_lshl_add_u32 v3, v4, 4, v3
s_add_u32 m0, s44, 67584
s_nop 0
buffer_load_dwordx4 v3, s[32:35], 0 offen nt lds
v_add_u32 v2, s43, v0
v_add_u32 v2, 2560, v2
v_mul_u32_u24 v3, 3543, v2
v_lshrrev_b32 v3, 18, v3
v_mul_u32_u24 v4, 74, v3
v_sub_u32 v4, v2, v4
v_min_u32 v4, 71, v4
v_cmp_le_u32 vcc, 32, v3
v_mov_b32 v5, s42
s_nop 0
v_cndmask_b32 v5, 0, v5, vcc
v_add3_u32 v3, v3, v5, s41
v_mul_u32_u24 v3, 1152, v3
v_lshl_add_u32 v3, v4, 4, v3
s_add_u32 m0, s44, 75776
s_nop 0
buffer_load_dwordx4 v3, s[32:35], 0 offen nt lds
v_add_u32 v2, s43, v0
v_add_u32 v2, 3072, v2
v_mul_u32_u24 v3, 3543, v2
v_lshrrev_b32 v3, 18, v3
v_mul_u32_u24 v4, 74, v3
v_sub_u32 v4, v2, v4
v_min_u32 v4, 71, v4
v_cmp_le_u32 vcc, 32, v3
v_mov_b32 v5, s42
s_nop 0
v_cndmask_b32 v5, 0, v5, vcc
v_add3_u32 v3, v3, v5, s41
v_mul_u32_u24 v3, 1152, v3
v_lshl_add_u32 v3, v4, 4, v3
s_add_u32 m0, s44, 83968
s_nop 0
buffer_load_dwordx4 v3, s[32:35], 0 offen nt lds
v_add_u32 v2, s43, v0
v_add_u32 v2, 3584, v2
v_mul_u32_u24 v3, 3543, v2
v_lshrrev_b32 v3, 18, v3
v_mul_u32_u24 v4, 74, v3
v_sub_u32 v4, v2, v4
v_min_u32 v4, 71, v4
v_cmp_le_u32 vcc, 32, v3
v_mov_b32 v5, s42
s_nop 0
v_cndmask_b32 v5, 0, v5, vcc
v_add3_u32 v3, v3, v5, s41
v_mul_u32_u24 v3, 1152, v3
v_lshl_add_u32 v3, v4, 4, v3
s_add_u32 m0, s44, 92160
s_nop 0
buffer_load_dwordx4 v3, s[32:35], 0 offen nt lds
v_add_u32 v2, s43, v0
v_add_u32 v2, 4096, v2
v_mul_u32_u24 v3, 3543, v2
v_lshrrev_b32 v3, 18, v3
v_mul_u32_u24 v4, 74, v3
v_sub_u32 v4, v2, v4
v_min_u32 v4, 71, v4
v_cmp_le_u32 vcc, 32, v3
v_mov_b32 v5, s42
s_nop 0
v_cndmask_b32 v5, 0, v5, vcc
v_add3_u32 v3, v3, v5, s41
v_mul_u32_u24 v3, 1152, v3
v_lshl_add_u32 v3, v4, 4, v3
s_add_u32 m0, s44, 100352
s_nop 0
buffer_load_dwordx4 v3, s[32:35], 0 offen nt lds
v_add_u32 v2, s43, v0
v_add_u32 v2, 4608, v2
v_mul_u32_u24 v3, 3543, v2
v_lshrrev_b32 v3, 18, v3
v_mul_u32_u24 v4, 74, v3
v_sub_u32 v4, v2, v4
v_min_u32 v4, 71, v4
v_cmp_le_u32 vcc, 32, v3
v_mov_b32 v5, s42
s_nop 0
v_cndmask_b32 v5, 0, v5, vcc
v_add3_u32 v3, v3, v5, s41
v_mul_u32_u24 v3, 1152, v3
v_lshl_add_u32 v3, v4, 4, v3
s_add_u32 m0, s44, 108544
s_nop 0
buffer_load_dwordx4 v3, s[32:35], 0 offen nt lds
v_lshlrev_b32 v2, 4, v0
v_and_b32 v6, 15, v0
v_lshrrev_b32 v7, 4, v0
v_bfe_u32 v14, v0, 2, 2
v_lshl_add_u32 v14, v7, 2, v14
v_mul_u32_u24 v14, 1184, v14
v_and_b32 v9, 3, v0
v_lshl_add_u32 v14, v9, 3, v14
s_lshl_b32 s41, s28, 5
s_add_u32 s41, s41, 34816
v_add_u32 v14, s41, v14
s_cmp_lt_u32 s31, 4
s_cbranch_scc0 Lw2j_42
s_lshl_b32 s41, s30, 1
s_lshr_b32 s42, s31, 1
s_add_u32 s41, s41, s42
s_and_b32 s42, s31, 1
s_branch Lw2k_43
Lw2j_42:
s_lshr_b32 s41, s30, 2
s_add_u32 s41, s41, 16
s_lshr_b32 s42, s30, 1
s_and_b32 s42, s42, 1
Lw2k_43:
s_lshl_b32 s41, s41, 10
s_lshl_b32 s42, s42, 3
s_add_u32 s41, s41, s42
s_mul_i32 s42, s28, 18432
s_add_u32 s41, s41, s42
s_add_u32 s46, s41, 9240576
s_lshl_b32 s41, s30, 4
s_lshl_b32 s42, s28, 1
s_add_u32 s41, s41, s42
s_mul_i32 s41, s41, 16896
s_add_u32 s47, s41, 4718592
s_lshl_b32 s41, s28, 12
v_add_u32 v9, s41, v2
s_lshl_b32 s41, s28, 10
v_add_u32 v10, s41, v2
s_lshr_b32 s41, s28, 1
s_lshl_b32 s41, s41, 10
s_and_b32 s42, s28, 1
s_lshl_b32 s42, s42, 3
s_add_u32 s41, s41, s42
v_add_u32 v11, s41, v2
s_cmp_eq_u32 s31, 0
s_cbranch_scc0 Lw2v_44
v_add_u32 v12, 0, v6
v_mul_u32_u24 v13, 3641, v12
v_lshrrev_b32 v13, 16, v13
v_mul_u32_u24 v13, 18, v13
s_mov_b32 s42, 0x100
s_and_b32 s43, s28, 3
s_lshl_b32 s43, s43, 3
s_lshr_b32 s42, s42, s43
s_and_b32 s42, s42, 0xff
s_lshl_b32 s42, s42, 4
v_lshlrev_b32 v12, 2, v7
v_add_u32 v12, s42, v12
v_sub_u32 v12, v12, v13
v_add_u32 v13, 0, v12
v_cmp_gt_u32 vcc, 18, v13
s_nop 1
v_cndmask_b32 v16, 0, 1.0, vcc
v_add_u32 v13, 1, v12
v_cmp_gt_u32 vcc, 18, v13
s_nop 1
v_cndmask_b32 v17, 0, 1.0, vcc
v_add_u32 v13, 2, v12
v_cmp_gt_u32 vcc, 18, v13
s_nop 1
v_cndmask_b32 v18, 0, 1.0, vcc
v_add_u32 v13, 3, v12
v_cmp_gt_u32 vcc, 18, v13
s_nop 1
v_cndmask_b32 v19, 0, 1.0, vcc
s_cmp_lt_u32 s28, 2
s_cselect_b32 s42, 1.0, 0
v_mul_f32 v16, s42, v16
v_mul_f32 v17, s42, v17
v_mul_f32 v18, s42, v18
v_mul_f32 v19, s42, v19
s_cmp_eq_u32 s28, 0
s_cbranch_scc0 Lwf_45
v_and_b32 v242, 15, v0
v_bfe_u32 v241, v0, 4, 1
s_cmp_eq_u32 s31, 4
s_cselect_b32 s68, 16, 0
v_mul_u32_u24 v241, s68, v241
v_add_u32 v242, v242, v241
s_lshl_b32 s68, s30, 4
s_add_u32 s68, s68, 64
v_add_u32 v242, s68, v242
v_lshlrev_b32 v242, 7, v242
v_add_u32 v242, 10166272, v242
s_mov_b32 s69, 0
Lwp_46:
buffer_load_dword v243, v242, s[64:67], 0 offen sc1
s_add_u32 s69, s69, 1
s_waitcnt vmcnt(0)
v_cmp_ne_u32 vcc, s70, v243
s_cmp_ge_u32 s69, 100000
s_cbranch_scc1 Lwf_45
s_cmp_lg_u64 vcc, 0
s_cbranch_scc1 Lwp_46
Lwf_45:
s_barrier
s_mov_b32 s69, 0
v_bfe_u32 v100, s92, 0, 8
v_bfe_u32 v101, s92, 8, 8
v_bfe_u32 v102, s92, 16, 8
v_bfe_u32 v103, s92, 24, 8
Lwp_47:
s_add_u32 s42, s47, 0
buffer_load_dwordx4 v[64:67], v2, s[64:67], s42 offen sc1
s_add_u32 s42, s47, 16896
buffer_load_dwordx4 v[68:71], v2, s[64:67], s42 offen sc1
s_add_u32 s42, s47, 1024
buffer_load_dwordx4 v[72:75], v2, s[64:67], s42 offen sc1
s_add_u32 s42, s47, 17920
buffer_load_dwordx4 v[76:79], v2, s[64:67], s42 offen sc1
s_add_u32 s69, s69, 1
s_waitcnt vmcnt(3)
v_xor_b32 v104, v64, v100
v_xor_b32 v105, v65, v101
v_xor_b32 v106, v66, v102
v_xor_b32 v107, v67, v103
v_or3_b32 v108, v104, v105, v106
v_or_b32 v108, v108, v107
s_waitcnt vmcnt(2)
v_xor_b32 v104, v68, v100
v_xor_b32 v105, v69, v101
v_xor_b32 v106, v70, v102
v_xor_b32 v107, v71, v103
v_or3_b32 v108, v108, v104, v105
v_or3_b32 v108, v108, v106, v107
s_waitcnt vmcnt(1)
v_xor_b32 v104, v72, v100
v_xor_b32 v105, v73, v101
v_xor_b32 v106, v74, v102
v_xor_b32 v107, v75, v103
v_or3_b32 v108, v108, v104, v105
v_or3_b32 v108, v108, v106, v107
s_waitcnt vmcnt(0)
v_xor_b32 v104, v76, v100
v_xor_b32 v105, v77, v101
v_xor_b32 v106, v78, v102
v_xor_b32 v107, v79, v103
v_or3_b32 v108, v108, v104, v105
v_or3_b32 v108, v108, v106, v107
v_and_b32 v108, 0xff, v108
v_cmp_ne_u32 vcc, 0, v108
s_cmp_ge_u32 s69, 100000
s_cbranch_scc1 Lwo_48
s_cmp_lg_u64 vcc, 0
s_cbranch_scc1 Lwp_47
Lwo_48:
v_pk_add_f32 v[64:65], v[64:65], v[68:69]
v_pk_add_f32 v[66:67], v[66:67], v[70:71]
ds_write_b128 v9, v[64:67] offset:0
v_pk_add_f32 v[72:73], v[72:73], v[76:77]
v_pk_add_f32 v[74:75], v[74:75], v[78:79]
ds_write_b128 v9, v[72:75] offset:1024
s_branch Lw2end_41
Lw2v_44:
s_cmp_eq_u32 s31, 1
s_cbranch_scc0 Lw2v_49
v_add_u32 v12, 16, v6
v_mul_u32_u24 v13, 3641, v12
v_lshrrev_b32 v13, 16, v13
v_mul_u32_u24 v13, 18, v13
s_mov_b32 s42, 0x20100
s_and_b32 s43, s28, 3
s_lshl_b32 s43, s43, 3
s_lshr_b32 s42, s42, s43
s_and_b32 s42, s42, 0xff
s_lshl_b32 s42, s42, 4
v_lshlrev_b32 v12, 2, v7
v_add_u32 v12, s42, v12
v_sub_u32 v12, v12, v13
v_add_u32 v13, 0, v12
v_cmp_gt_u32 vcc, 18, v13
s_nop 1
v_cndmask_b32 v16, 0, 1.0, vcc
v_add_u32 v13, 1, v12
v_cmp_gt_u32 vcc, 18, v13
s_nop 1
v_cndmask_b32 v17, 0, 1.0, vcc
v_add_u32 v13, 2, v12
v_cmp_gt_u32 vcc, 18, v13
s_nop 1
v_cndmask_b32 v18, 0, 1.0, vcc
v_add_u32 v13, 3, v12
v_cmp_gt_u32 vcc, 18, v13
s_nop 1
v_cndmask_b32 v19, 0, 1.0, vcc
s_cmp_lt_u32 s28, 3
s_cselect_b32 s42, 1.0, 0
v_mul_f32 v16, s42, v16
v_mul_f32 v17, s42, v17
v_mul_f32 v18, s42, v18
v_mul_f32 v19, s42, v19
s_cmp_eq_u32 s28, 0
s_cbranch_scc0 Lwf_50
v_and_b32 v242, 15, v0
v_bfe_u32 v241, v0, 4, 1
s_cmp_eq_u32 s31, 4
s_cselect_b32 s68, 16, 0
v_mul_u32_u24 v241, s68, v241
v_add_u32 v242, v242, v241
s_lshl_b32 s68, s30, 4
s_add_u32 s68, s68, 64
v_add_u32 v242, s68, v242
v_lshlrev_b32 v242, 7, v242
v_add_u32 v242, 10166272, v242
s_mov_b32 s69, 0
Lwp_51:
buffer_load_dword v243, v242, s[64:67], 0 offen sc1
s_add_u32 s69, s69, 1
s_waitcnt vmcnt(0)
v_cmp_ne_u32 vcc, s70, v243
s_cmp_ge_u32 s69, 100000
s_cbranch_scc1 Lwf_50
s_cmp_lg_u64 vcc, 0
s_cbranch_scc1 Lwp_51
Lwf_50:
s_barrier
s_mov_b32 s69, 0
v_bfe_u32 v100, s92, 0, 8
v_bfe_u32 v101, s92, 8, 8
v_bfe_u32 v102, s92, 16, 8
v_bfe_u32 v103, s92, 24, 8
Lwp_52:
s_add_u32 s42, s47, 2048
buffer_load_dwordx4 v[64:67], v2, s[64:67], s42 offen sc1
s_add_u32 s42, s47, 18944
buffer_load_dwordx4 v[68:71], v2, s[64:67], s42 offen sc1
s_add_u32 s42, s47, 3072
buffer_load_dwordx4 v[72:75], v2, s[64:67], s42 offen sc1
s_add_u32 s42, s47, 19968
buffer_load_dwordx4 v[76:79], v2, s[64:67], s42 offen sc1
s_add_u32 s42, s47, 4096
buffer_load_dwordx4 v[80:83], v2, s[64:67], s42 offen sc1
s_add_u32 s42, s47, 20992
buffer_load_dwordx4 v[84:87], v2, s[64:67], s42 offen sc1
s_add_u32 s69, s69, 1
s_waitcnt vmcnt(5)
v_xor_b32 v104, v64, v100
v_xor_b32 v105, v65, v101
v_xor_b32 v106, v66, v102
v_xor_b32 v107, v67, v103
v_or3_b32 v108, v104, v105, v106
v_or_b32 v108, v108, v107
s_waitcnt vmcnt(4)
v_xor_b32 v104, v68, v100
v_xor_b32 v105, v69, v101
v_xor_b32 v106, v70, v102
v_xor_b32 v107, v71, v103
v_or3_b32 v108, v108, v104, v105
v_or3_b32 v108, v108, v106, v107
s_waitcnt vmcnt(3)
v_xor_b32 v104, v72, v100
v_xor_b32 v105, v73, v101
v_xor_b32 v106, v74, v102
v_xor_b32 v107, v75, v103
v_or3_b32 v108, v108, v104, v105
v_or3_b32 v108, v108, v106, v107
s_waitcnt vmcnt(2)
v_xor_b32 v104, v76, v100
v_xor_b32 v105, v77, v101
v_xor_b32 v106, v78, v102
v_xor_b32 v107, v79, v103
v_or3_b32 v108, v108, v104, v105
v_or3_b32 v108, v108, v106, v107
s_waitcnt vmcnt(1)
v_xor_b32 v104, v80, v100
v_xor_b32 v105, v81, v101
v_xor_b32 v106, v82, v102
v_xor_b32 v107, v83, v103
v_or3_b32 v108, v108, v104, v105
v_or3_b32 v108, v108, v106, v107
s_waitcnt vmcnt(0)
v_xor_b32 v104, v84, v100
v_xor_b32 v105, v85, v101
v_xor_b32 v106, v86, v102
v_xor_b32 v107, v87, v103
v_or3_b32 v108, v108, v104, v105
v_or3_b32 v108, v108, v106, v107
v_and_b32 v108, 0xff, v108
v_cmp_ne_u32 vcc, 0, v108
s_cmp_ge_u32 s69, 100000
s_cbranch_scc1 Lwo_53
s_cmp_lg_u64 vcc, 0
s_cbranch_scc1 Lwp_52
Lwo_53:
v_pk_add_f32 v[64:65], v[64:65], v[68:69]
v_pk_add_f32 v[66:67], v[66:67], v[70:71]
ds_write_b128 v9, v[64:67] offset:0
v_pk_add_f32 v[72:73], v[72:73], v[76:77]
v_pk_add_f32 v[74:75], v[74:75], v[78:79]
ds_write_b128 v9, v[72:75] offset:1024
v_pk_add_f32 v[80:81], v[80:81], v[84:85]
v_pk_add_f32 v[82:83], v[82:83], v[86:87]
ds_write_b128 v9, v[80:83] offset:2048
s_branch Lw2end_41
Lw2v_49:
s_cmp_eq_u32 s31, 2
s_cbranch_scc0 Lw2v_54
v_add_u32 v12, 32, v6
v_mul_u32_u24 v13, 3641, v12
v_lshrrev_b32 v13, 16, v13
v_mul_u32_u24 v13, 18, v13
s_mov_b32 s42, 0x30201
s_and_b32 s43, s28, 3
s_lshl_b32 s43, s43, 3
s_lshr_b32 s42, s42, s43
s_and_b32 s42, s42, 0xff
s_lshl_b32 s42, s42, 4
v_lshlrev_b32 v12, 2, v7
v_add_u32 v12, s42, v12
v_sub_u32 v12, v12, v13
v_add_u32 v13, 0, v12
v_cmp_gt_u32 vcc, 18, v13
s_nop 1
v_cndmask_b32 v16, 0, 1.0, vcc
v_add_u32 v13, 1, v12
v_cmp_gt_u32 vcc, 18, v13
s_nop 1
v_cndmask_b32 v17, 0, 1.0, vcc
v_add_u32 v13, 2, v12
v_cmp_gt_u32 vcc, 18, v13
s_nop 1
v_cndmask_b32 v18, 0, 1.0, vcc
v_add_u32 v13, 3, v12
v_cmp_gt_u32 vcc, 18, v13
s_nop 1
v_cndmask_b32 v19, 0, 1.0, vcc
s_cmp_lt_u32 s28, 3
s_cselect_b32 s42, 1.0, 0
v_mul_f32 v16, s42, v16
v_mul_f32 v17, s42, v17
v_mul_f32 v18, s42, v18
v_mul_f32 v19, s42, v19
s_cmp_eq_u32 s28, 0
s_cbranch_scc0 Lwf_55
v_and_b32 v242, 15, v0
v_bfe_u32 v241, v0, 4, 1
s_cmp_eq_u32 s31, 4
s_cselect_b32 s68, 16, 0
v_mul_u32_u24 v241, s68, v241
v_add_u32 v242, v242, v241
s_lshl_b32 s68, s30, 4
s_add_u32 s68, s68, 64
v_add_u32 v242, s68, v242
v_lshlrev_b32 v242, 7, v242
v_add_u32 v242, 10166272, v242
s_mov_b32 s69, 0
Lwp_56:
buffer_load_dword v243, v242, s[64:67], 0 offen sc1
s_add_u32 s69, s69, 1
s_waitcnt vmcnt(0)
v_cmp_ne_u32 vcc, s70, v243
s_cmp_ge_u32 s69, 100000
s_cbranch_scc1 Lwf_55
s_cmp_lg_u64 vcc, 0
s_cbranch_scc1 Lwp_56
Lwf_55:
s_barrier
s_mov_b32 s69, 0
v_bfe_u32 v100, s92, 0, 8
v_bfe_u32 v101, s92, 8, 8
v_bfe_u32 v102, s92, 16, 8
v_bfe_u32 v103, s92, 24, 8
Lwp_57:
s_add_u32 s42, s47, 5120
buffer_load_dwordx4 v[64:67], v2, s[64:67], s42 offen sc1
s_add_u32 s42, s47, 22016
buffer_load_dwordx4 v[68:71], v2, s[64:67], s42 offen sc1
s_add_u32 s42, s47, 6144
buffer_load_dwordx4 v[72:75], v2, s[64:67], s42 offen sc1
s_add_u32 s42, s47, 23040
buffer_load_dwordx4 v[76:79], v2, s[64:67], s42 offen sc1
s_add_u32 s42, s47, 7168
buffer_load_dwordx4 v[80:83], v2, s[64:67], s42 offen sc1
s_add_u32 s42, s47, 24064
buffer_load_dwordx4 v[84:87], v2, s[64:67], s42 offen sc1
s_add_u32 s69, s69, 1
s_waitcnt vmcnt(5)
v_xor_b32 v104, v64, v100
v_xor_b32 v105, v65, v101
v_xor_b32 v106, v66, v102
v_xor_b32 v107, v67, v103
v_or3_b32 v108, v104, v105, v106
v_or_b32 v108, v108, v107
s_waitcnt vmcnt(4)
v_xor_b32 v104, v68, v100
v_xor_b32 v105, v69, v101
v_xor_b32 v106, v70, v102
v_xor_b32 v107, v71, v103
v_or3_b32 v108, v108, v104, v105
v_or3_b32 v108, v108, v106, v107
s_waitcnt vmcnt(3)
v_xor_b32 v104, v72, v100
v_xor_b32 v105, v73, v101
v_xor_b32 v106, v74, v102
v_xor_b32 v107, v75, v103
v_or3_b32 v108, v108, v104, v105
v_or3_b32 v108, v108, v106, v107
s_waitcnt vmcnt(2)
v_xor_b32 v104, v76, v100
v_xor_b32 v105, v77, v101
v_xor_b32 v106, v78, v102
v_xor_b32 v107, v79, v103
v_or3_b32 v108, v108, v104, v105
v_or3_b32 v108, v108, v106, v107
s_waitcnt vmcnt(1)
v_xor_b32 v104, v80, v100
v_xor_b32 v105, v81, v101
v_xor_b32 v106, v82, v102
v_xor_b32 v107, v83, v103
v_or3_b32 v108, v108, v104, v105
v_or3_b32 v108, v108, v106, v107
s_waitcnt vmcnt(0)
v_xor_b32 v104, v84, v100
v_xor_b32 v105, v85, v101
v_xor_b32 v106, v86, v102
v_xor_b32 v107, v87, v103
v_or3_b32 v108, v108, v104, v105
v_or3_b32 v108, v108, v106, v107
v_and_b32 v108, 0xff, v108
v_cmp_ne_u32 vcc, 0, v108
s_cmp_ge_u32 s69, 100000
s_cbranch_scc1 Lwo_58
s_cmp_lg_u64 vcc, 0
s_cbranch_scc1 Lwp_57
Lwo_58:
v_pk_add_f32 v[64:65], v[64:65], v[68:69]
v_pk_add_f32 v[66:67], v[66:67], v[70:71]
ds_write_b128 v9, v[64:67] offset:0
v_pk_add_f32 v[72:73], v[72:73], v[76:77]
v_pk_add_f32 v[74:75], v[74:75], v[78:79]
ds_write_b128 v9, v[72:75] offset:1024
v_pk_add_f32 v[80:81], v[80:81], v[84:85]
v_pk_add_f32 v[82:83], v[82:83], v[86:87]
ds_write_b128 v9, v[80:83] offset:2048
s_branch Lw2end_41
Lw2v_54:
s_cmp_eq_u32 s31, 3
s_cbranch_scc0 Lw2v_59
v_add_u32 v12, 48, v6
v_mul_u32_u24 v13, 3641, v12
v_lshrrev_b32 v13, 16, v13
v_mul_u32_u24 v13, 18, v13
s_mov_b32 s42, 0x40302
s_and_b32 s43, s28, 3
s_lshl_b32 s43, s43, 3
s_lshr_b32 s42, s42, s43
s_and_b32 s42, s42, 0xff
s_lshl_b32 s42, s42, 4
v_lshlrev_b32 v12, 2, v7
v_add_u32 v12, s42, v12
v_sub_u32 v12, v12, v13
v_add_u32 v13, 0, v12
v_cmp_gt_u32 vcc, 18, v13
s_nop 1
v_cndmask_b32 v16, 0, 1.0, vcc
v_add_u32 v13, 1, v12
v_cmp_gt_u32 vcc, 18, v13
s_nop 1
v_cndmask_b32 v17, 0, 1.0, vcc
v_add_u32 v13, 2, v12
v_cmp_gt_u32 vcc, 18, v13
s_nop 1
v_cndmask_b32 v18, 0, 1.0, vcc
v_add_u32 v13, 3, v12
v_cmp_gt_u32 vcc, 18, v13
s_nop 1
v_cndmask_b32 v19, 0, 1.0, vcc
s_cmp_lt_u32 s28, 3
s_cselect_b32 s42, 1.0, 0
v_mul_f32 v16, s42, v16
v_mul_f32 v17, s42, v17
v_mul_f32 v18, s42, v18
v_mul_f32 v19, s42, v19
s_cmp_eq_u32 s28, 0
s_cbranch_scc0 Lwf_60
v_and_b32 v242, 15, v0
v_bfe_u32 v241, v0, 4, 1
s_cmp_eq_u32 s31, 4
s_cselect_b32 s68, 16, 0
v_mul_u32_u24 v241, s68, v241
v_add_u32 v242, v242, v241
s_lshl_b32 s68, s30, 4
s_add_u32 s68, s68, 64
v_add_u32 v242, s68, v242
v_lshlrev_b32 v242, 7, v242
v_add_u32 v242, 10166272, v242
s_mov_b32 s69, 0
Lwp_61:
buffer_load_dword v243, v242, s[64:67], 0 offen sc1
s_add_u32 s69, s69, 1
s_waitcnt vmcnt(0)
v_cmp_ne_u32 vcc, s70, v243
s_cmp_ge_u32 s69, 100000
s_cbranch_scc1 Lwf_60
s_cmp_lg_u64 vcc, 0
s_cbranch_scc1 Lwp_61
Lwf_60:
s_barrier
s_mov_b32 s69, 0
v_bfe_u32 v100, s92, 0, 8
v_bfe_u32 v101, s92, 8, 8
v_bfe_u32 v102, s92, 16, 8
v_bfe_u32 v103, s92, 24, 8
Lwp_62:
s_add_u32 s42, s47, 8192
buffer_load_dwordx4 v[64:67], v2, s[64:67], s42 offen sc1
s_add_u32 s42, s47, 25088
buffer_load_dwordx4 v[68:71], v2, s[64:67], s42 offen sc1
s_add_u32 s42, s47, 9216
buffer_load_dwordx4 v[72:75], v2, s[64:67], s42 offen sc1
s_add_u32 s42, s47, 26112
buffer_load_dwordx4 v[76:79], v2, s[64:67], s42 offen sc1
s_add_u32 s42, s47, 10240
buffer_load_dwordx4 v[80:83], v2, s[64:67], s42 offen sc1
s_add_u32 s42, s47, 27136
buffer_load_dwordx4 v[84:87], v2, s[64:67], s42 offen sc1
s_add_u32 s69, s69, 1
s_waitcnt vmcnt(5)
v_xor_b32 v104, v64, v100
v_xor_b32 v105, v65, v101
v_xor_b32 v106, v66, v102
v_xor_b32 v107, v67, v103
v_or3_b32 v108, v104, v105, v106
v_or_b32 v108, v108, v107
s_waitcnt vmcnt(4)
v_xor_b32 v104, v68, v100
v_xor_b32 v105, v69, v101
v_xor_b32 v106, v70, v102
v_xor_b32 v107, v71, v103
v_or3_b32 v108, v108, v104, v105
v_or3_b32 v108, v108, v106, v107
s_waitcnt vmcnt(3)
v_xor_b32 v104, v72, v100
v_xor_b32 v105, v73, v101
v_xor_b32 v106, v74, v102
v_xor_b32 v107, v75, v103
v_or3_b32 v108, v108, v104, v105
v_or3_b32 v108, v108, v106, v107
s_waitcnt vmcnt(2)
v_xor_b32 v104, v76, v100
v_xor_b32 v105, v77, v101
v_xor_b32 v106, v78, v102
v_xor_b32 v107, v79, v103
v_or3_b32 v108, v108, v104, v105
v_or3_b32 v108, v108, v106, v107
s_waitcnt vmcnt(1)
v_xor_b32 v104, v80, v100
v_xor_b32 v105, v81, v101
v_xor_b32 v106, v82, v102
v_xor_b32 v107, v83, v103
v_or3_b32 v108, v108, v104, v105
v_or3_b32 v108, v108, v106, v107
s_waitcnt vmcnt(0)
v_xor_b32 v104, v84, v100
v_xor_b32 v105, v85, v101
v_xor_b32 v106, v86, v102
v_xor_b32 v107, v87, v103
v_or3_b32 v108, v108, v104, v105
v_or3_b32 v108, v108, v106, v107
v_and_b32 v108, 0xff, v108
v_cmp_ne_u32 vcc, 0, v108
s_cmp_ge_u32 s69, 100000
s_cbranch_scc1 Lwo_63
s_cmp_lg_u64 vcc, 0
s_cbranch_scc1 Lwp_62
Lwo_63:
v_pk_add_f32 v[64:65], v[64:65], v[68:69]
v_pk_add_f32 v[66:67], v[66:67], v[70:71]
ds_write_b128 v9, v[64:67] offset:0
v_pk_add_f32 v[72:73], v[72:73], v[76:77]
v_pk_add_f32 v[74:75], v[74:75], v[78:79]
ds_write_b128 v9, v[72:75] offset:1024
v_pk_add_f32 v[80:81], v[80:81], v[84:85]
v_pk_add_f32 v[82:83], v[82:83], v[86:87]
ds_write_b128 v9, v[80:83] offset:2048
s_branch Lw2end_41
Lw2v_59:
s_cmp_eq_u32 s31, 4
s_cbranch_scc0 Lw2v_64
v_cmp_le_u32 vcc, 8, v6
v_subrev_u32 v8, 128, v2
s_nop 0
v_cndmask_b32 v8, v2, v8, vcc
s_cmp_ge_u32 s28, 2
s_cselect_b32 s42, 8, 0
v_subrev_u32 v12, s42, v6
v_cmp_gt_u32 vcc, 8, v12
v_mov_b32 v13, 54
v_mov_b32 v15, 0x10000
v_cndmask_b32 v13, v15, v13, vcc
s_mov_b32 s42, 0x4030403
s_and_b32 s43, s28, 3
s_lshl_b32 s43, s43, 3
s_lshr_b32 s42, s42, s43
s_and_b32 s42, s42, 0xff
s_lshl_b32 s42, s42, 4
v_lshlrev_b32 v12, 2, v7
v_add_u32 v12, s42, v12
v_sub_u32 v12, v12, v13
v_add_u32 v13, 0, v12
v_cmp_gt_u32 vcc, 18, v13
s_nop 1
v_cndmask_b32 v16, 0, 1.0, vcc
v_add_u32 v13, 1, v12
v_cmp_gt_u32 vcc, 18, v13
s_nop 1
v_cndmask_b32 v17, 0, 1.0, vcc
v_add_u32 v13, 2, v12
v_cmp_gt_u32 vcc, 18, v13
s_nop 1
v_cndmask_b32 v18, 0, 1.0, vcc
v_add_u32 v13, 3, v12
v_cmp_gt_u32 vcc, 18, v13
s_nop 1
v_cndmask_b32 v19, 0, 1.0, vcc
s_cmp_lt_u32 s28, 4
s_cselect_b32 s42, 1.0, 0
v_mul_f32 v16, s42, v16
v_mul_f32 v17, s42, v17
v_mul_f32 v18, s42, v18
v_mul_f32 v19, s42, v19
s_cmp_eq_u32 s28, 0
s_cbranch_scc0 Lwf_65
v_and_b32 v242, 15, v0
v_bfe_u32 v241, v0, 4, 1
s_cmp_eq_u32 s31, 4
s_cselect_b32 s68, 16, 0
v_mul_u32_u24 v241, s68, v241
v_add_u32 v242, v242, v241
s_lshl_b32 s68, s30, 4
s_add_u32 s68, s68, 64
v_add_u32 v242, s68, v242
v_lshlrev_b32 v242, 7, v242
v_add_u32 v242, 10166272, v242
s_mov_b32 s69, 0
Lwp_66:
buffer_load_dword v243, v242, s[64:67], 0 offen sc1
s_add_u32 s69, s69, 1
s_waitcnt vmcnt(0)
v_cmp_ne_u32 vcc, s70, v243
s_cmp_ge_u32 s69, 100000
s_cbranch_scc1 Lwf_65
s_cmp_lg_u64 vcc, 0
s_cbranch_scc1 Lwp_66
Lwf_65:
s_barrier
s_mov_b32 s69, 0
v_bfe_u32 v100, s92, 0, 8
v_bfe_u32 v101, s92, 8, 8
v_bfe_u32 v102, s92, 16, 8
v_bfe_u32 v103, s92, 24, 8
Lwp_67:
s_add_u32 s42, s47, 11264
buffer_load_dwordx4 v[64:67], v2, s[64:67], s42 offen sc1
s_add_u32 s42, s47, 28160
buffer_load_dwordx4 v[68:71], v2, s[64:67], s42 offen sc1
s_add_u32 s42, s47, 12288
buffer_load_dwordx4 v[72:75], v2, s[64:67], s42 offen sc1
s_add_u32 s42, s47, 29184
buffer_load_dwordx4 v[76:79], v2, s[64:67], s42 offen sc1
s_add_u32 s42, s47, 281600
buffer_load_dwordx4 v[80:83], v8, s[64:67], s42 offen sc1
s_add_u32 s42, s47, 298496
buffer_load_dwordx4 v[84:87], v8, s[64:67], s42 offen sc1
s_add_u32 s42, s47, 282624
buffer_load_dwordx4 v[88:91], v8, s[64:67], s42 offen sc1
s_add_u32 s42, s47, 299520
buffer_load_dwordx4 v[92:95], v8, s[64:67], s42 offen sc1
s_add_u32 s69, s69, 1
s_waitcnt vmcnt(7)
v_xor_b32 v104, v64, v100
v_xor_b32 v105, v65, v101
v_xor_b32 v106, v66, v102
v_xor_b32 v107, v67, v103
v_or3_b32 v108, v104, v105, v106
v_or_b32 v108, v108, v107
s_waitcnt vmcnt(6)
v_xor_b32 v104, v68, v100
v_xor_b32 v105, v69, v101
v_xor_b32 v106, v70, v102
v_xor_b32 v107, v71, v103
v_or3_b32 v108, v108, v104, v105
v_or3_b32 v108, v108, v106, v107
s_waitcnt vmcnt(5)
v_xor_b32 v104, v72, v100
v_xor_b32 v105, v73, v101
v_xor_b32 v106, v74, v102
v_xor_b32 v107, v75, v103
v_or3_b32 v108, v108, v104, v105
v_or3_b32 v108, v108, v106, v107
s_waitcnt vmcnt(4)
v_xor_b32 v104, v76, v100
v_xor_b32 v105, v77, v101
v_xor_b32 v106, v78, v102
v_xor_b32 v107, v79, v103
v_or3_b32 v108, v108, v104, v105
v_or3_b32 v108, v108, v106, v107
s_waitcnt vmcnt(3)
v_xor_b32 v104, v80, v100
v_xor_b32 v105, v81, v101
v_xor_b32 v106, v82, v102
v_xor_b32 v107, v83, v103
v_or3_b32 v108, v108, v104, v105
v_or3_b32 v108, v108, v106, v107
s_waitcnt vmcnt(2)
v_xor_b32 v104, v84, v100
v_xor_b32 v105, v85, v101
v_xor_b32 v106, v86, v102
v_xor_b32 v107, v87, v103
v_or3_b32 v108, v108, v104, v105
v_or3_b32 v108, v108, v106, v107
s_waitcnt vmcnt(1)
v_xor_b32 v104, v88, v100
v_xor_b32 v105, v89, v101
v_xor_b32 v106, v90, v102
v_xor_b32 v107, v91, v103
v_or3_b32 v108, v108, v104, v105
v_or3_b32 v108, v108, v106, v107
s_waitcnt vmcnt(0)
v_xor_b32 v104, v92, v100
v_xor_b32 v105, v93, v101
v_xor_b32 v106, v94, v102
v_xor_b32 v107, v95, v103
v_or3_b32 v108, v108, v104, v105
v_or3_b32 v108, v108, v106, v107
v_and_b32 v108, 0xff, v108
v_cmp_ne_u32 vcc, 0, v108
s_cmp_ge_u32 s69, 100000
s_cbranch_scc1 Lwo_68
s_cmp_lg_u64 vcc, 0
s_cbranch_scc1 Lwp_67
Lwo_68:
v_pk_add_f32 v[64:65], v[64:65], v[68:69]
v_pk_add_f32 v[66:67], v[66:67], v[70:71]
ds_write_b128 v9, v[64:67] offset:0
v_pk_add_f32 v[72:73], v[72:73], v[76:77]
v_pk_add_f32 v[74:75], v[74:75], v[78:79]
ds_write_b128 v9, v[72:75] offset:1024
v_pk_add_f32 v[80:81], v[80:81], v[84:85]
v_pk_add_f32 v[82:83], v[82:83], v[86:87]
ds_write_b128 v9, v[80:83] offset:2048
v_pk_add_f32 v[88:89], v[88:89], v[92:93]
v_pk_add_f32 v[90:91], v[90:91], v[94:95]
ds_write_b128 v9, v[88:91] offset:3072
s_branch Lw2end_41
Lw2v_64:
Lw2end_41:
s_waitcnt lgkmcnt(0)
s_barrier
s_cmp_ge_u32 s28, 4
s_cbranch_scc1 Lw2skip_69
ds_read_b128 v[64:67], v10 offset:0
ds_read_b128 v[68:71], v10 offset:4096
ds_read_b128 v[72:75], v10 offset:8192
ds_read_b128 v[76:79], v10 offset:12288
ds_read_b128 v[80:83], v10 offset:16384
ds_read_b128 v[84:87], v10 offset:20480
ds_read_b128 v[88:91], v10 offset:24576
ds_read_b128 v[92:95], v10 offset:28672
s_waitcnt lgkmcnt(6)
v_pk_add_f32 v[64:65], v[64:65], v[68:69]
v_pk_add_f32 v[66:67], v[66:67], v[70:71]
s_waitcnt lgkmcnt(5)
v_pk_add_f32 v[64:65], v[64:65], v[72:73]
v_pk_add_f32 v[66:67], v[66:67], v[74:75]
s_waitcnt lgkmcnt(4)
v_pk_add_f32 v[64:65], v[64:65], v[76:77]
v_pk_add_f32 v[66:67], v[66:67], v[78:79]
s_waitcnt lgkmcnt(3)
v_pk_add_f32 v[64:65], v[64:65], v[80:81]
v_pk_add_f32 v[66:67], v[66:67], v[82:83]
s_waitcnt lgkmcnt(2)
v_pk_add_f32 v[64:65], v[64:65], v[84:85]
v_pk_add_f32 v[66:67], v[66:67], v[86:87]
s_waitcnt lgkmcnt(1)
v_pk_add_f32 v[64:65], v[64:65], v[88:89]
v_pk_add_f32 v[66:67], v[66:67], v[90:91]
s_waitcnt lgkmcnt(0)
v_pk_add_f32 v[64:65], v[64:65], v[92:93]
v_pk_add_f32 v[66:67], v[66:67], v[94:95]
v_cmp_neq_f32 vcc, 0, v16
s_nop 1
v_cndmask_b32 v64, 0, v64, vcc
v_cmp_neq_f32 vcc, 0, v17
s_nop 1
v_cndmask_b32 v65, 0, v65, vcc
v_cmp_neq_f32 vcc, 0, v18
s_nop 1
v_cndmask_b32 v66, 0, v66, vcc
v_cmp_neq_f32 vcc, 0, v19
s_nop 1
v_cndmask_b32 v67, 0, v67, vcc
v_cvt_pk_bf16_f32 v68, v64, v65
v_cvt_pk_bf16_f32 v69, v66, v67
ds_write_b64 v11, v[68:69] offset:32768
Lw2skip_69:
s_waitcnt vmcnt(0) lgkmcnt(0)
s_barrier
ds_read_b128 v[64:67], v2 offset:32768
ds_read_b128 v[68:71], v2 offset:33792
ds_read_b64_tr_b16 v[72:73], v14 offset:0
ds_read_b64_tr_b16 v[74:75], v14 offset:18944
ds_read_b64_tr_b16 v[76:77], v14 offset:37888
ds_read_b64_tr_b16 v[78:79], v14 offset:56832
ds_read_b64_tr_b16 v[80:81], v14 offset:256
ds_read_b64_tr_b16 v[82:83], v14 offset:19200
ds_read_b64_tr_b16 v[84:85], v14 offset:38144
ds_read_b64_tr_b16 v[86:87], v14 offset:57088
ds_read_b64_tr_b16 v[88:89], v14 offset:512
ds_read_b64_tr_b16 v[90:91], v14 offset:19456
ds_read_b64_tr_b16 v[92:93], v14 offset:38400
ds_read_b64_tr_b16 v[94:95], v14 offset:57344
ds_read_b64_tr_b16 v[96:97], v14 offset:768
ds_read_b64_tr_b16 v[98:99], v14 offset:19712
ds_read_b64_tr_b16 v[100:101], v14 offset:38656
ds_read_b64_tr_b16 v[102:103], v14 offset:57600
ds_read_b64_tr_b16 v[104:105], v14 offset:1024
ds_read_b64_tr_b16 v[106:107], v14 offset:19968
ds_read_b64_tr_b16 v[108:109], v14 offset:38912
ds_read_b64_tr_b16 v[110:111], v14 offset:57856
s_waitcnt lgkmcnt(15)
v_mfma_f32_16x16x32_bf16 v[120:123], v[64:67], v[72:75], 0
s_waitcnt lgkmcnt(15)
v_mfma_f32_16x16x32_bf16 v[120:123], v[68:71], v[76:79], v[120:123]
s_waitcnt lgkmcnt(14)
v_mfma_f32_16x16x32_bf16 v[124:127], v[64:67], v[80:83], 0
s_waitcnt lgkmcnt(12)
v_mfma_f32_16x16x32_bf16 v[124:127], v[68:71], v[84:87], v[124:127]
s_waitcnt lgkmcnt(10)
v_mfma_f32_16x16x32_bf16 v[128:131], v[64:67], v[88:91], 0
s_waitcnt lgkmcnt(8)
v_mfma_f32_16x16x32_bf16 v[128:131], v[68:71], v[92:95], v[128:131]
s_waitcnt lgkmcnt(6)
v_mfma_f32_16x16x32_bf16 v[132:135], v[64:67], v[96:99], 0
s_waitcnt lgkmcnt(4)
v_mfma_f32_16x16x32_bf16 v[132:135], v[68:71], v[100:103], v[132:135]
s_cmp_ge_u32 s28, 4
s_cbranch_scc1 Lw2t_70
s_waitcnt lgkmcnt(2)
v_mfma_f32_16x16x32_bf16 v[136:139], v[64:67], v[104:107], 0
s_waitcnt lgkmcnt(0)
v_mfma_f32_16x16x32_bf16 v[136:139], v[68:71], v[108:111], v[136:139]
Lw2t_70:
v_cvt_pk_bf16_f32 v140, v120, v121
v_cvt_pk_bf16_f32 v141, v122, v123
s_add_u32 s42, s46, 0
buffer_store_dwordx2 v[140:141], v2, s[64:67], s42 offen sc1
v_cvt_pk_bf16_f32 v142, v124, v125
v_cvt_pk_bf16_f32 v143, v126, v127
s_add_u32 s42, s46, 147456
buffer_store_dwordx2 v[142:143], v2, s[64:67], s42 offen sc1
v_cvt_pk_bf16_f32 v144, v128, v129
v_cvt_pk_bf16_f32 v145, v130, v131
s_add_u32 s42, s46, 294912
buffer_store_dwordx2 v[144:145], v2, s[64:67], s42 offen sc1
v_cvt_pk_bf16_f32 v146, v132, v133
v_cvt_pk_bf16_f32 v147, v134, v135
s_add_u32 s42, s46, 442368
buffer_store_dwordx2 v[146:147], v2, s[64:67], s42 offen sc1
s_cmp_ge_u32 s28, 4
s_cbranch_scc1 Lw2s_71
v_cvt_pk_bf16_f32 v148, v136, v137
v_cvt_pk_bf16_f32 v149, v138, v139
s_add_u32 s42, s46, 589824
buffer_store_dwordx2 v[148:149], v2, s[64:67], s42 offen sc1
Lw2s_71:
s_waitcnt vmcnt(0)
s_barrier
s_cmp_eq_u32 s28, 0
s_cbranch_scc0 Lpub_72
s_add_u32 s68, s73, 256
s_lshl_b32 s68, s68, 7
s_add_u32 s68, s68, 10166272
v_mov_b32 v240, 0
v_mov_b32 v241, s70
s_mov_b64 s[74:75], exec
s_mov_b64 exec, 1
buffer_store_dword v241, v240, s[64:67], s68 offen sc1
s_mov_b64 exec, s[74:75]
Lpub_72:
s_sub_u32 s59, s72, 8
s_branch concat_heads__linear_attn_block__ssm_conv_h3__prompt_kernel_out
concat_heads__linear_attn_block__ssm_conv_h3__prompt_kernel_nob1:
s_sub_u32 s93, s73, 36
s_mov_b32 s29, s93
s_lshr_b32 s41, s28, 1
s_and_b32 s89, s28, 1
s_lshl_b32 s88, s29, 2
s_add_u32 s88, s88, s41
s_mul_i32 s90, s41, 16640
s_add_u32 s90, s90, 55168
s_mul_i32 s94, s41, 4576
s_add_u32 s94, s94, 36864
s_lshl_b32 s42, s88, 12
s_add_u32 s32, s18, s42
s_addc_u32 s33, s19, 0
s_mov_b32 s34, 0x1000
s_mov_b32 s35, 0x20000
s_mov_b32 s36, s20
s_mov_b32 s37, s21
s_mov_b32 s38, 0x480
s_mov_b32 s39, 0x20000
v_lshlrev_b32 v41, 4, v0
s_lshl_b32 s41, s89, 11
v_add_u32 v42, s41, v41
buffer_load_dwordx4 v[28:31], v42, s[32:35], 0 offen nt
v_subrev_u32 v43, 8, v42
buffer_load_dwordx2 v[24:25], v43, s[32:35], 0 offen nt
v_add_u32 v42, 1024, v42
buffer_load_dwordx4 v[36:39], v42, s[32:35], 0 offen nt
v_subrev_u32 v43, 8, v42
buffer_load_dwordx2 v[32:33], v43, s[32:35], 0 offen nt
s_lshl_b32 s41, s88, 1
v_mov_b32 v43, s41
buffer_load_ushort v40, v43, s[36:39], 0 offen
s_waitcnt vmcnt(0)
s_barrier
s_cmp_eq_u32 s28, 0
s_cbranch_scc0 Lhint_73
s_add_u32 s68, s73, 0
s_lshl_b32 s68, s68, 7
s_add_u32 s68, s68, 10166272
v_mov_b32 v240, 0
v_mov_b32 v241, s70
s_mov_b64 exec, 1
buffer_store_dword v241, v240, s[64:67], s68 offen sc1
s_mov_b64 exec, -1
Lhint_73:
v_mov_b32 v44, 0
v_mov_b32 v45, 0
v_mov_b32 v46, 0
v_mov_b32 v47, 0
v_lshlrev_b32 v41, 4, v0
s_mov_b64 s[52:53], exec
s_cmp_eq_u32 s89, 0
s_cbranch_scc0 Lcz_74
v_lshrrev_b32 v42, 2, v0
v_mul_u32_u24 v42, 4160, v42
v_and_b32 v43, 3, v0
v_lshl_add_u32 v42, v43, 4, v42
v_add_u32 v42, s90, v42
s_mov_b64 exec, 0xffff
ds_write_b128 v42, v[44:47]
s_branch Lce_75
Lcz_74:
v_add_u32 v42, s94, v41
s_mov_b64 exec, 0x3fffffff
ds_write_b128 v42, v[44:47]
Lce_75:
s_mov_b64 exec, s[52:53]
s_lshl_b32 s41, s89, 11
s_add_u32 s41, s41, s90
v_add_u32 v42, s41, v41
ds_write_b128 v42, v[28:31] offset:64
v_mov_b32 v48, v25
v_mov_b32 v49, v28
v_mov_b32 v50, v29
v_mov_b32 v51, v30
ds_write_b128 v42, v[48:51] offset:8384
v_alignbit_b32 v52, v25, v24, 16
v_alignbit_b32 v53, v28, v25, 16
v_alignbit_b32 v54, v29, v28, 16
v_alignbit_b32 v55, v30, v29, 16
ds_write_b128 v42, v[52:55] offset:12544
v_mov_b32 v56, v53
v_mov_b32 v57, v54
v_mov_b32 v58, v55
v_alignbit_b32 v59, v31, v30, 16
ds_write_b128 v42, v[56:59] offset:4224
ds_write_b128 v42, v[36:39] offset:1088
v_mov_b32 v48, v33
v_mov_b32 v49, v36
v_mov_b32 v50, v37
v_mov_b32 v51, v38
ds_write_b128 v42, v[48:51] offset:9408
v_alignbit_b32 v52, v33, v32, 16
v_alignbit_b32 v53, v36, v33, 16
v_alignbit_b32 v54, v37, v36, 16
v_alignbit_b32 v55, v38, v37, 16
ds_write_b128 v42, v[52:55] offset:13568
v_mov_b32 v56, v53
v_mov_b32 v57, v54
v_mov_b32 v58, v55
v_alignbit_b32 v59, v39, v38, 16
ds_write_b128 v42, v[56:59] offset:5248
v_lshrrev_b32 v60, 4, v0
v_bfe_u32 v61, v0, 2, 2
v_and_b32 v62, 3, v0
v_mul_u32_u24 v10, 4160, v61
v_lshl_add_u32 v10, v62, 3, v10
v_lshlrev_b32 v11, 4, v60
v_sub_u32 v10, v10, v11
s_lshl_b32 s41, s89, 8
s_add_u32 s41, s41, s90
s_add_u32 s41, s41, 88
v_add_u32 v10, s41, v10
v_and_b32 v11, 15, v0
v_lshlrev_b32 v11, 5, v11
v_lshl_add_u32 v11, v60, 4, v11
s_lshl_b32 s41, s89, 8
s_sub_u32 s41, s94, s41
v_add_u32 v11, s41, v11
s_cmp_eq_u32 s28, 7
s_cbranch_scc0 Lwf_76
v_and_b32 v242, 31, v0
s_bfe_u32 s68, s93, 0x10004
s_lshl_b32 s68, s68, 5
s_add_u32 s68, s68, 0
v_add_u32 v242, s68, v242
v_lshlrev_b32 v242, 7, v242
v_add_u32 v242, 10166272, v242
s_mov_b32 s69, 0
Lwp_77:
buffer_load_dword v243, v242, s[64:67], 0 offen sc1
s_add_u32 s69, s69, 1
s_waitcnt vmcnt(0)
v_cmp_ne_u32 vcc, s70, v243
s_cmp_ge_u32 s69, 100000
s_cbranch_scc1 Lwf_76
s_cmp_lg_u64 vcc, 0
s_cbranch_scc1 Lwp_77
Lwf_76:
s_barrier
v_lshlrev_b32 v41, 4, v0
s_lshl_b32 s41, s88, 12
s_lshl_b32 s42, s89, 11
s_add_u32 s41, s41, s42
s_add_u32 s41, s41, 0
s_add_u32 s42, s42, s94
s_add_u32 m0, s42, 480
s_add_u32 s43, s41, 0
buffer_load_dwordx4 v41, s[64:67], s43 offen sc1 lds
s_add_u32 m0, s42, 1504
s_add_u32 s43, s41, 1024
buffer_load_dwordx4 v41, s[64:67], s43 offen sc1 lds
s_waitcnt vmcnt(0) lgkmcnt(0)
s_barrier
concat_heads__linear_attn_block__ssm_conv_h3__prompt_kernel_convmain:
ds_read_b128 v[160:163], v11 offset:448
ds_read_b64_tr_b16 v[96:97], v10 offset:8
ds_read_b64_tr_b16 v[98:99], v10 offset:0
ds_read_b128 v[164:167], v11 offset:960
ds_read_b64_tr_b16 v[100:101], v10 offset:520
ds_read_b64_tr_b16 v[102:103], v10 offset:512
v_and_b32 v8, 15, v0
v_lshlrev_b32 v8, 5, v8
v_lshrrev_b32 v9, 4, v0
v_lshl_add_u32 v8, v9, 3, v8
s_lshl_b32 s41, s89, 11
s_add_u32 s41, s41, s94
s_add_u32 s41, s41, 480
v_add_u32 v8, s41, v8
ds_read_b64 v[224:225], v8 offset:0
ds_read_b64 v[226:227], v8 offset:512
ds_read_b64 v[228:229], v8 offset:1024
ds_read_b64 v[230:231], v8 offset:1536
ds_read_b128 v[168:171], v11 offset:1472
ds_read_b64_tr_b16 v[104:105], v10 offset:1032
ds_read_b64_tr_b16 v[106:107], v10 offset:1024
ds_read_b128 v[172:175], v11 offset:1984
ds_read_b64_tr_b16 v[108:109], v10 offset:1544
ds_read_b64_tr_b16 v[110:111], v10 offset:1536
ds_read_b128 v[176:179], v11 offset:2496
ds_read_b64_tr_b16 v[112:113], v10 offset:2056
ds_read_b64_tr_b16 v[114:115], v10 offset:2048
ds_read_b128 v[180:183], v11 offset:3008
ds_read_b64_tr_b16 v[116:117], v10 offset:2568
ds_read_b64_tr_b16 v[118:119], v10 offset:2560
ds_read_b128 v[184:187], v11 offset:3520
ds_read_b64_tr_b16 v[120:121], v10 offset:3080
ds_read_b64_tr_b16 v[122:123], v10 offset:3072
ds_read_b128 v[188:191], v11 offset:4032
ds_read_b64_tr_b16 v[124:125], v10 offset:3592
ds_read_b64_tr_b16 v[126:127], v10 offset:3584
s_waitcnt lgkmcnt(15)
v_mfma_f32_16x16x32_bf16 v[64:67], v[96:99], v[160:163], 0
v_mfma_f32_16x16x32_bf16 v[68:71], v[96:99], v[164:167], 0
v_mfma_f32_16x16x32_bf16 v[68:71], v[100:103], v[160:163], v[68:71]
v_mfma_f32_16x16x32_bf16 v[72:75], v[100:103], v[164:167], 0
v_mfma_f32_16x16x32_bf16 v[72:75], v[96:99], v[168:171], v[72:75]
v_mfma_f32_16x16x32_bf16 v[76:79], v[100:103], v[168:171], 0
v_mfma_f32_16x16x32_bf16 v[72:75], v[104:107], v[160:163], v[72:75]
v_mfma_f32_16x16x32_bf16 v[76:79], v[104:107], v[164:167], v[76:79]
ds_read_b128 v[192:195], v11 offset:384
v_mfma_f32_16x16x32_bf16 v[80:83], v[104:107], v[168:171], 0
ds_read_b64_tr_b16 v[128:129], v10 offset:72
s_waitcnt lgkmcnt(15)
v_mfma_f32_16x16x32_bf16 v[76:79], v[96:99], v[172:175], v[76:79]
ds_read_b64_tr_b16 v[130:131], v10 offset:64
v_mfma_f32_16x16x32_bf16 v[80:83], v[100:103], v[172:175], v[80:83]
ds_read_b128 v[196:199], v11 offset:896
v_mfma_f32_16x16x32_bf16 v[84:87], v[104:107], v[172:175], 0
ds_read_b64_tr_b16 v[132:133], v10 offset:584
s_waitcnt lgkmcnt(15)
v_mfma_f32_16x16x32_bf16 v[76:79], v[108:111], v[160:163], v[76:79]
ds_read_b64_tr_b16 v[134:135], v10 offset:576
v_mfma_f32_16x16x32_bf16 v[80:83], v[108:111], v[164:167], v[80:83]
ds_read_b128 v[200:203], v11 offset:1408
v_mfma_f32_16x16x32_bf16 v[84:87], v[108:111], v[168:171], v[84:87]
ds_read_b64_tr_b16 v[136:137], v10 offset:1096
v_mfma_f32_16x16x32_bf16 v[88:91], v[108:111], v[172:175], 0
ds_read_b64_tr_b16 v[138:139], v10 offset:1088
v_mfma_f32_16x16x32_bf16 v[80:83], v[96:99], v[176:179], v[80:83]
ds_read_b128 v[204:207], v11 offset:1920
v_mfma_f32_16x16x32_bf16 v[84:87], v[100:103], v[176:179], v[84:87]
ds_read_b64_tr_b16 v[140:141], v10 offset:1608
v_mfma_f32_16x16x32_bf16 v[88:91], v[104:107], v[176:179], v[88:91]
ds_read_b64_tr_b16 v[142:143], v10 offset:1600
v_mfma_f32_16x16x32_bf16 v[92:95], v[108:111], v[176:179], 0
ds_read_b128 v[208:211], v11 offset:2432
s_waitcnt lgkmcnt(15)
v_mfma_f32_16x16x32_bf16 v[80:83], v[112:115], v[160:163], v[80:83]
ds_read_b64_tr_b16 v[144:145], v10 offset:2120
v_mfma_f32_16x16x32_bf16 v[84:87], v[112:115], v[164:167], v[84:87]
ds_read_b64_tr_b16 v[146:147], v10 offset:2112
v_mfma_f32_16x16x32_bf16 v[88:91], v[112:115], v[168:171], v[88:91]
ds_read_b128 v[212:215], v11 offset:2944
v_mfma_f32_16x16x32_bf16 v[92:95], v[112:115], v[172:175], v[92:95]
ds_read_b64_tr_b16 v[148:149], v10 offset:2632
v_mfma_f32_16x16x32_bf16 v[84:87], v[96:99], v[180:183], v[84:87]
ds_read_b64_tr_b16 v[150:151], v10 offset:2624
v_mfma_f32_16x16x32_bf16 v[88:91], v[100:103], v[180:183], v[88:91]
ds_read_b128 v[216:219], v11 offset:3456
v_mfma_f32_16x16x32_bf16 v[92:95], v[104:107], v[180:183], v[92:95]
ds_read_b64_tr_b16 v[152:153], v10 offset:3144
v_mfma_f32_16x16x32_bf16 v[84:87], v[116:119], v[160:163], v[84:87]
ds_read_b64_tr_b16 v[154:155], v10 offset:3136
v_mfma_f32_16x16x32_bf16 v[88:91], v[116:119], v[164:167], v[88:91]
ds_read_b128 v[220:223], v11 offset:3968
v_mfma_f32_16x16x32_bf16 v[92:95], v[116:119], v[168:171], v[92:95]
ds_read_b64_tr_b16 v[156:157], v10 offset:3656
v_mfma_f32_16x16x32_bf16 v[88:91], v[96:99], v[184:187], v[88:91]
ds_read_b64_tr_b16 v[158:159], v10 offset:3648
v_mfma_f32_16x16x32_bf16 v[92:95], v[100:103], v[184:187], v[92:95]
v_mfma_f32_16x16x32_bf16 v[88:91], v[120:123], v[160:163], v[88:91]
v_mfma_f32_16x16x32_bf16 v[92:95], v[120:123], v[164:167], v[92:95]
v_mfma_f32_16x16x32_bf16 v[92:95], v[96:99], v[188:191], v[92:95]
s_waitcnt lgkmcnt(15)
v_mfma_f32_16x16x32_bf16 v[92:95], v[124:127], v[160:163], v[92:95]
v_mfma_f32_16x16x32_bf16 v[64:67], v[128:131], v[192:195], v[64:67]
v_mfma_f32_16x16x32_bf16 v[68:71], v[128:131], v[196:199], v[68:71]
v_mfma_f32_16x16x32_bf16 v[68:71], v[132:135], v[192:195], v[68:71]
v_lshlrev_b32 v2, 4, v0
s_lshl_b32 s41, s28, 12
v_add_u32 v6, s41, v2
v_mfma_f32_16x16x32_bf16 v[72:75], v[132:135], v[196:199], v[72:75]
v_mfma_f32_16x16x32_bf16 v[72:75], v[128:131], v[200:203], v[72:75]
v_mfma_f32_16x16x32_bf16 v[76:79], v[132:135], v[200:203], v[76:79]
s_xor_b32 s42, s28, 1
s_lshl_b32 s42, s42, 12
v_add_u32 v7, s42, v2
v_mfma_f32_16x16x32_bf16 v[72:75], v[136:139], v[192:195], v[72:75]
v_mfma_f32_16x16x32_bf16 v[76:79], v[136:139], v[196:199], v[76:79]
ds_read_b128 v[160:163], v11 offset:320
v_mfma_f32_16x16x32_bf16 v[80:83], v[136:139], v[200:203], v[80:83]
ds_read_b64_tr_b16 v[96:97], v10 offset:136
v_lshlrev_b32 v40, 16, v40
s_mov_b32 s45, 0xffff0000
s_waitcnt lgkmcnt(15)
v_mfma_f32_16x16x32_bf16 v[76:79], v[128:131], v[204:207], v[76:79]
ds_read_b64_tr_b16 v[98:99], v10 offset:128
v_mfma_f32_16x16x32_bf16 v[80:83], v[132:135], v[204:207], v[80:83]
ds_read_b128 v[164:167], v11 offset:832
v_mfma_f32_16x16x32_bf16 v[84:87], v[136:139], v[204:207], v[84:87]
ds_read_b64_tr_b16 v[100:101], v10 offset:648
v_lshlrev_b32 v12, 16, v224
v_and_b32 v13, s45, v224
v_lshlrev_b32 v14, 16, v225
v_and_b32 v15, s45, v225
s_waitcnt lgkmcnt(15)
v_mfma_f32_16x16x32_bf16 v[76:79], v[140:143], v[192:195], v[76:79]
ds_read_b64_tr_b16 v[102:103], v10 offset:640
v_mfma_f32_16x16x32_bf16 v[80:83], v[140:143], v[196:199], v[80:83]
ds_read_b128 v[168:171], v11 offset:1344
v_mfma_f32_16x16x32_bf16 v[84:87], v[140:143], v[200:203], v[84:87]
ds_read_b64_tr_b16 v[104:105], v10 offset:1160
v_mul_f32 v12, v12, v40
v_mul_f32 v13, v13, v40
v_mul_f32 v14, v14, v40
v_mul_f32 v15, v15, v40
v_mfma_f32_16x16x32_bf16 v[88:91], v[140:143], v[204:207], v[88:91]
ds_read_b64_tr_b16 v[106:107], v10 offset:1152
v_mfma_f32_16x16x32_bf16 v[80:83], v[128:131], v[208:211], v[80:83]
ds_read_b128 v[172:175], v11 offset:1856
v_mfma_f32_16x16x32_bf16 v[84:87], v[132:135], v[208:211], v[84:87]
ds_read_b64_tr_b16 v[108:109], v10 offset:1672
v_lshlrev_b32 v16, 16, v226
v_and_b32 v17, s45, v226
v_lshlrev_b32 v18, 16, v227
v_and_b32 v19, s45, v227
v_mfma_f32_16x16x32_bf16 v[88:91], v[136:139], v[208:211], v[88:91]
ds_read_b64_tr_b16 v[110:111], v10 offset:1664
v_mfma_f32_16x16x32_bf16 v[92:95], v[140:143], v[208:211], v[92:95]
ds_read_b128 v[176:179], v11 offset:2368
s_waitcnt lgkmcnt(15)
v_mfma_f32_16x16x32_bf16 v[80:83], v[144:147], v[192:195], v[80:83]
ds_read_b64_tr_b16 v[112:113], v10 offset:2184
v_mul_f32 v16, v16, v40
v_mul_f32 v17, v17, v40
v_mul_f32 v18, v18, v40
v_mul_f32 v19, v19, v40
v_mfma_f32_16x16x32_bf16 v[84:87], v[144:147], v[196:199], v[84:87]
ds_read_b64_tr_b16 v[114:115], v10 offset:2176
v_mfma_f32_16x16x32_bf16 v[88:91], v[144:147], v[200:203], v[88:91]
ds_read_b128 v[180:183], v11 offset:2880
v_mfma_f32_16x16x32_bf16 v[92:95], v[144:147], v[204:207], v[92:95]
ds_read_b64_tr_b16 v[116:117], v10 offset:2696
v_lshlrev_b32 v20, 16, v228
v_and_b32 v21, s45, v228
v_lshlrev_b32 v22, 16, v229
v_and_b32 v23, s45, v229
v_mfma_f32_16x16x32_bf16 v[84:87], v[128:131], v[212:215], v[84:87]
ds_read_b64_tr_b16 v[118:119], v10 offset:2688
v_mfma_f32_16x16x32_bf16 v[88:91], v[132:135], v[212:215], v[88:91]
ds_read_b128 v[184:187], v11 offset:3392
v_mfma_f32_16x16x32_bf16 v[92:95], v[136:139], v[212:215], v[92:95]
ds_read_b64_tr_b16 v[120:121], v10 offset:3208
v_mul_f32 v20, v20, v40
v_mul_f32 v21, v21, v40
v_mul_f32 v22, v22, v40
v_mul_f32 v23, v23, v40
v_mfma_f32_16x16x32_bf16 v[84:87], v[148:151], v[192:195], v[84:87]
ds_read_b64_tr_b16 v[122:123], v10 offset:3200
v_mfma_f32_16x16x32_bf16 v[88:91], v[148:151], v[196:199], v[88:91]
ds_read_b128 v[188:191], v11 offset:3904
v_mfma_f32_16x16x32_bf16 v[92:95], v[148:151], v[200:203], v[92:95]
ds_read_b64_tr_b16 v[124:125], v10 offset:3720
v_lshlrev_b32 v24, 16, v230
v_and_b32 v25, s45, v230
v_lshlrev_b32 v26, 16, v231
v_and_b32 v27, s45, v231
v_mfma_f32_16x16x32_bf16 v[88:91], v[128:131], v[216:219], v[88:91]
ds_read_b64_tr_b16 v[126:127], v10 offset:3712
v_mfma_f32_16x16x32_bf16 v[92:95], v[132:135], v[216:219], v[92:95]
v_mfma_f32_16x16x32_bf16 v[88:91], v[152:155], v[192:195], v[88:91]
v_mul_f32 v24, v24, v40
v_mul_f32 v25, v25, v40
v_mul_f32 v26, v26, v40
v_mul_f32 v27, v27, v40
v_mfma_f32_16x16x32_bf16 v[92:95], v[152:155], v[196:199], v[92:95]
v_mfma_f32_16x16x32_bf16 v[92:95], v[128:131], v[220:223], v[92:95]
s_waitcnt lgkmcnt(15)
v_mfma_f32_16x16x32_bf16 v[92:95], v[156:159], v[192:195], v[92:95]
v_mfma_f32_16x16x32_bf16 v[64:67], v[96:99], v[160:163], v[64:67]
v_mfma_f32_16x16x32_bf16 v[68:71], v[96:99], v[164:167], v[68:71]
v_mfma_f32_16x16x32_bf16 v[68:71], v[100:103], v[160:163], v[68:71]
v_mfma_f32_16x16x32_bf16 v[72:75], v[100:103], v[164:167], v[72:75]
v_mfma_f32_16x16x32_bf16 v[72:75], v[96:99], v[168:171], v[72:75]
v_mfma_f32_16x16x32_bf16 v[76:79], v[100:103], v[168:171], v[76:79]
v_mfma_f32_16x16x32_bf16 v[72:75], v[104:107], v[160:163], v[72:75]
v_mfma_f32_16x16x32_bf16 v[76:79], v[104:107], v[164:167], v[76:79]
ds_read_b128 v[192:195], v11 offset:256
v_mfma_f32_16x16x32_bf16 v[80:83], v[104:107], v[168:171], v[80:83]
ds_read_b64_tr_b16 v[128:129], v10 offset:200
s_waitcnt lgkmcnt(15)
v_mfma_f32_16x16x32_bf16 v[76:79], v[96:99], v[172:175], v[76:79]
ds_read_b64_tr_b16 v[130:131], v10 offset:192
v_mfma_f32_16x16x32_bf16 v[80:83], v[100:103], v[172:175], v[80:83]
ds_read_b128 v[196:199], v11 offset:768
v_mfma_f32_16x16x32_bf16 v[84:87], v[104:107], v[172:175], v[84:87]
ds_read_b64_tr_b16 v[132:133], v10 offset:712
s_waitcnt lgkmcnt(15)
v_mfma_f32_16x16x32_bf16 v[76:79], v[108:111], v[160:163], v[76:79]
ds_read_b64_tr_b16 v[134:135], v10 offset:704
v_mfma_f32_16x16x32_bf16 v[80:83], v[108:111], v[164:167], v[80:83]
ds_read_b128 v[200:203], v11 offset:1280
v_mfma_f32_16x16x32_bf16 v[84:87], v[108:111], v[168:171], v[84:87]
ds_read_b64_tr_b16 v[136:137], v10 offset:1224
v_mfma_f32_16x16x32_bf16 v[88:91], v[108:111], v[172:175], v[88:91]
ds_read_b64_tr_b16 v[138:139], v10 offset:1216
v_mfma_f32_16x16x32_bf16 v[80:83], v[96:99], v[176:179], v[80:83]
ds_read_b128 v[204:207], v11 offset:1792
v_mfma_f32_16x16x32_bf16 v[84:87], v[100:103], v[176:179], v[84:87]
ds_read_b64_tr_b16 v[140:141], v10 offset:1736
v_mfma_f32_16x16x32_bf16 v[88:91], v[104:107], v[176:179], v[88:91]
ds_read_b64_tr_b16 v[142:143], v10 offset:1728
v_mfma_f32_16x16x32_bf16 v[92:95], v[108:111], v[176:179], v[92:95]
ds_read_b128 v[208:211], v11 offset:2304
s_waitcnt lgkmcnt(15)
v_mfma_f32_16x16x32_bf16 v[80:83], v[112:115], v[160:163], v[80:83]
ds_read_b64_tr_b16 v[144:145], v10 offset:2248
v_mfma_f32_16x16x32_bf16 v[84:87], v[112:115], v[164:167], v[84:87]
ds_read_b64_tr_b16 v[146:147], v10 offset:2240
v_mfma_f32_16x16x32_bf16 v[88:91], v[112:115], v[168:171], v[88:91]
ds_read_b128 v[212:215], v11 offset:2816
v_mfma_f32_16x16x32_bf16 v[92:95], v[112:115], v[172:175], v[92:95]
ds_read_b64_tr_b16 v[148:149], v10 offset:2760
v_mfma_f32_16x16x32_bf16 v[84:87], v[96:99], v[180:183], v[84:87]
ds_read_b64_tr_b16 v[150:151], v10 offset:2752
v_mfma_f32_16x16x32_bf16 v[88:91], v[100:103], v[180:183], v[88:91]
ds_read_b128 v[216:219], v11 offset:3328
v_mfma_f32_16x16x32_bf16 v[92:95], v[104:107], v[180:183], v[92:95]
ds_read_b64_tr_b16 v[152:153], v10 offset:3272
v_mfma_f32_16x16x32_bf16 v[84:87], v[116:119], v[160:163], v[84:87]
ds_read_b64_tr_b16 v[154:155], v10 offset:3264
v_mfma_f32_16x16x32_bf16 v[88:91], v[116:119], v[164:167], v[88:91]
ds_read_b128 v[220:223], v11 offset:3840
v_mfma_f32_16x16x32_bf16 v[92:95], v[116:119], v[168:171], v[92:95]
ds_read_b64_tr_b16 v[156:157], v10 offset:3784
v_mfma_f32_16x16x32_bf16 v[88:91], v[96:99], v[184:187], v[88:91]
ds_read_b64_tr_b16 v[158:159], v10 offset:3776
v_mfma_f32_16x16x32_bf16 v[92:95], v[100:103], v[184:187], v[92:95]
v_mfma_f32_16x16x32_bf16 v[88:91], v[120:123], v[160:163], v[88:91]
v_mfma_f32_16x16x32_bf16 v[92:95], v[120:123], v[164:167], v[92:95]
v_mfma_f32_16x16x32_bf16 v[92:95], v[96:99], v[188:191], v[92:95]
s_waitcnt lgkmcnt(15)
v_mfma_f32_16x16x32_bf16 v[92:95], v[124:127], v[160:163], v[92:95]
v_mfma_f32_16x16x32_bf16 v[64:67], v[128:131], v[192:195], v[64:67]
v_mfma_f32_16x16x32_bf16 v[68:71], v[128:131], v[196:199], v[68:71]
v_mfma_f32_16x16x32_bf16 v[68:71], v[132:135], v[192:195], v[68:71]
v_mfma_f32_16x16x32_bf16 v[72:75], v[132:135], v[196:199], v[72:75]
v_mfma_f32_16x16x32_bf16 v[72:75], v[128:131], v[200:203], v[72:75]
v_mfma_f32_16x16x32_bf16 v[76:79], v[132:135], v[200:203], v[76:79]
v_mfma_f32_16x16x32_bf16 v[72:75], v[136:139], v[192:195], v[72:75]
v_mfma_f32_16x16x32_bf16 v[76:79], v[136:139], v[196:199], v[76:79]
v_mfma_f32_16x16x32_bf16 v[80:83], v[136:139], v[200:203], v[80:83]
s_waitcnt lgkmcnt(14)
v_mfma_f32_16x16x32_bf16 v[76:79], v[128:131], v[204:207], v[76:79]
v_mfma_f32_16x16x32_bf16 v[80:83], v[132:135], v[204:207], v[80:83]
v_mfma_f32_16x16x32_bf16 v[84:87], v[136:139], v[204:207], v[84:87]
s_waitcnt lgkmcnt(12)
v_mfma_f32_16x16x32_bf16 v[76:79], v[140:143], v[192:195], v[76:79]
v_mfma_f32_16x16x32_bf16 v[80:83], v[140:143], v[196:199], v[80:83]
v_mfma_f32_16x16x32_bf16 v[84:87], v[140:143], v[200:203], v[84:87]
v_mfma_f32_16x16x32_bf16 v[88:91], v[140:143], v[204:207], v[88:91]
s_waitcnt lgkmcnt(11)
v_mfma_f32_16x16x32_bf16 v[80:83], v[128:131], v[208:211], v[80:83]
v_mfma_f32_16x16x32_bf16 v[84:87], v[132:135], v[208:211], v[84:87]
v_mfma_f32_16x16x32_bf16 v[88:91], v[136:139], v[208:211], v[88:91]
v_mfma_f32_16x16x32_bf16 v[92:95], v[140:143], v[208:211], v[92:95]
s_waitcnt lgkmcnt(9)
v_mfma_f32_16x16x32_bf16 v[80:83], v[144:147], v[192:195], v[80:83]
v_mfma_f32_16x16x32_bf16 v[84:87], v[144:147], v[196:199], v[84:87]
v_mfma_f32_16x16x32_bf16 v[88:91], v[144:147], v[200:203], v[88:91]
v_mfma_f32_16x16x32_bf16 v[92:95], v[144:147], v[204:207], v[92:95]
s_waitcnt lgkmcnt(8)
v_mfma_f32_16x16x32_bf16 v[84:87], v[128:131], v[212:215], v[84:87]
v_mfma_f32_16x16x32_bf16 v[88:91], v[132:135], v[212:215], v[88:91]
v_mfma_f32_16x16x32_bf16 v[92:95], v[136:139], v[212:215], v[92:95]
s_waitcnt lgkmcnt(6)
v_mfma_f32_16x16x32_bf16 v[84:87], v[148:151], v[192:195], v[84:87]
v_mfma_f32_16x16x32_bf16 v[88:91], v[148:151], v[196:199], v[88:91]
v_mfma_f32_16x16x32_bf16 v[92:95], v[148:151], v[200:203], v[92:95]
s_waitcnt lgkmcnt(5)
v_mfma_f32_16x16x32_bf16 v[88:91], v[128:131], v[216:219], v[88:91]
v_mfma_f32_16x16x32_bf16 v[92:95], v[132:135], v[216:219], v[92:95]
s_waitcnt lgkmcnt(3)
v_mfma_f32_16x16x32_bf16 v[88:91], v[152:155], v[192:195], v[88:91]
v_mfma_f32_16x16x32_bf16 v[92:95], v[152:155], v[196:199], v[92:95]
s_waitcnt lgkmcnt(2)
v_mfma_f32_16x16x32_bf16 v[92:95], v[128:131], v[220:223], v[92:95]
s_waitcnt lgkmcnt(0)
v_mfma_f32_16x16x32_bf16 v[92:95], v[156:159], v[192:195], v[92:95]
s_cmp_eq_u32 s89, 0
s_cbranch_scc0 Lcx_78
ds_write_b128 v6, v[80:83] offset:0
ds_write_b128 v6, v[84:87] offset:1024
ds_write_b128 v6, v[88:91] offset:2048
s_nop 2
ds_write_b128 v6, v[92:95] offset:3072
v_pk_add_f32 v[64:65], v[64:65], v[12:13]
v_pk_add_f32 v[66:67], v[66:67], v[14:15]
v_pk_add_f32 v[68:69], v[68:69], v[16:17]
v_pk_add_f32 v[70:71], v[70:71], v[18:19]
v_pk_add_f32 v[72:73], v[72:73], v[20:21]
v_pk_add_f32 v[74:75], v[74:75], v[22:23]
v_pk_add_f32 v[76:77], v[76:77], v[24:25]
v_pk_add_f32 v[78:79], v[78:79], v[26:27]
s_waitcnt lgkmcnt(0)
s_barrier
ds_read_b128 v[96:99], v7 offset:0
ds_read_b128 v[100:103], v7 offset:1024
ds_read_b128 v[104:107], v7 offset:2048
ds_read_b128 v[108:111], v7 offset:3072
s_waitcnt lgkmcnt(3)
v_pk_add_f32 v[64:65], v[64:65], v[96:97]
v_pk_add_f32 v[66:67], v[66:67], v[98:99]
v_cvt_pk_bf16_f32 v124, v64, v65
v_cvt_pk_bf16_f32 v125, v66, v67
s_waitcnt lgkmcnt(2)
v_pk_add_f32 v[68:69], v[68:69], v[100:101]
v_pk_add_f32 v[70:71], v[70:71], v[102:103]
v_cvt_pk_bf16_f32 v126, v68, v69
v_cvt_pk_bf16_f32 v127, v70, v71
s_waitcnt lgkmcnt(1)
v_pk_add_f32 v[72:73], v[72:73], v[104:105]
v_pk_add_f32 v[74:75], v[74:75], v[106:107]
v_cvt_pk_bf16_f32 v128, v72, v73
v_cvt_pk_bf16_f32 v129, v74, v75
s_waitcnt lgkmcnt(0)
v_pk_add_f32 v[76:77], v[76:77], v[108:109]
v_pk_add_f32 v[78:79], v[78:79], v[110:111]
v_cvt_pk_bf16_f32 v130, v76, v77
v_cvt_pk_bf16_f32 v131, v78, v79
ds_write_b64 v8, v[124:125] offset:0
ds_write_b64 v8, v[126:127] offset:512
ds_write_b64 v8, v[128:129] offset:1024
ds_write_b64 v8, v[130:131] offset:1536
s_branch Lcy_79
Lcx_78:
ds_write_b128 v6, v[64:67] offset:0
ds_write_b128 v6, v[68:71] offset:1024
ds_write_b128 v6, v[72:75] offset:2048
ds_write_b128 v6, v[76:79] offset:3072
v_pk_add_f32 v[80:81], v[80:81], v[12:13]
v_pk_add_f32 v[82:83], v[82:83], v[14:15]
v_pk_add_f32 v[84:85], v[84:85], v[16:17]
v_pk_add_f32 v[86:87], v[86:87], v[18:19]
v_pk_add_f32 v[88:89], v[88:89], v[20:21]
v_pk_add_f32 v[90:91], v[90:91], v[22:23]
v_pk_add_f32 v[92:93], v[92:93], v[24:25]
v_pk_add_f32 v[94:95], v[94:95], v[26:27]
s_waitcnt lgkmcnt(0)
s_barrier
ds_read_b128 v[96:99], v7 offset:0
ds_read_b128 v[100:103], v7 offset:1024
ds_read_b128 v[104:107], v7 offset:2048
ds_read_b128 v[108:111], v7 offset:3072
s_waitcnt lgkmcnt(3)
v_pk_add_f32 v[80:81], v[80:81], v[96:97]
v_pk_add_f32 v[82:83], v[82:83], v[98:99]
v_cvt_pk_bf16_f32 v124, v80, v81
v_cvt_pk_bf16_f32 v125, v82, v83
s_waitcnt lgkmcnt(2)
v_pk_add_f32 v[84:85], v[84:85], v[100:101]
v_pk_add_f32 v[86:87], v[86:87], v[102:103]
v_cvt_pk_bf16_f32 v126, v84, v85
v_cvt_pk_bf16_f32 v127, v86, v87
s_waitcnt lgkmcnt(1)
v_pk_add_f32 v[88:89], v[88:89], v[104:105]
v_pk_add_f32 v[90:91], v[90:91], v[106:107]
v_cvt_pk_bf16_f32 v128, v88, v89
v_cvt_pk_bf16_f32 v129, v90, v91
s_waitcnt lgkmcnt(0)
v_pk_add_f32 v[92:93], v[92:93], v[108:109]
v_pk_add_f32 v[94:95], v[94:95], v[110:111]
v_cvt_pk_bf16_f32 v130, v92, v93
v_cvt_pk_bf16_f32 v131, v94, v95
ds_write_b64 v8, v[124:125] offset:0
ds_write_b64 v8, v[126:127] offset:512
ds_write_b64 v8, v[128:129] offset:1024
ds_write_b64 v8, v[130:131] offset:1536
Lcy_79:
s_sub_u32 s43, s28, 6
s_lshl_b32 s43, s43, 1
s_mul_i32 s41, s43, 4576
s_add_u32 s41, s41, 37344
v_add_u32 v9, s41, v2
s_and_b32 s41, s88, -4
s_add_u32 s41, s41, s43
s_lshl_b32 s41, s41, 12
s_add_u32 s41, s41, 2359296
s_waitcnt lgkmcnt(0)
s_barrier
s_cmp_lt_u32 s28, 6
s_cbranch_scc1 Ly2_80
ds_read_b128 v[132:135], v9 offset:0
ds_read_b128 v[136:139], v9 offset:1024
ds_read_b128 v[140:143], v9 offset:2048
ds_read_b128 v[144:147], v9 offset:3072
ds_read_b128 v[148:151], v9 offset:4576
ds_read_b128 v[152:155], v9 offset:5600
ds_read_b128 v[156:159], v9 offset:6624
ds_read_b128 v[160:163], v9 offset:7648
s_waitcnt lgkmcnt(7)
s_add_u32 s42, s41, 0
buffer_store_dwordx4 v[132:135], v2, s[64:67], s42 offen sc1
s_waitcnt lgkmcnt(6)
s_add_u32 s42, s41, 1024
buffer_store_dwordx4 v[136:139], v2, s[64:67], s42 offen sc1
s_waitcnt lgkmcnt(5)
s_add_u32 s42, s41, 2048
buffer_store_dwordx4 v[140:143], v2, s[64:67], s42 offen sc1
s_waitcnt lgkmcnt(4)
s_add_u32 s42, s41, 3072
buffer_store_dwordx4 v[144:147], v2, s[64:67], s42 offen sc1
s_waitcnt lgkmcnt(3)
s_add_u32 s42, s41, 4096
buffer_store_dwordx4 v[148:151], v2, s[64:67], s42 offen sc1
s_waitcnt lgkmcnt(2)
s_add_u32 s42, s41, 5120
buffer_store_dwordx4 v[152:155], v2, s[64:67], s42 offen sc1
s_waitcnt lgkmcnt(1)
s_add_u32 s42, s41, 6144
buffer_store_dwordx4 v[156:159], v2, s[64:67], s42 offen sc1
s_waitcnt lgkmcnt(0)
s_add_u32 s42, s41, 7168
buffer_store_dwordx4 v[160:163], v2, s[64:67], s42 offen sc1
Ly2_80:
s_cmp_ge_u32 s72, 8
s_cselect_b32 s41, 1, 0
s_cmp_lt_u32 s72, 16
s_cselect_b32 s41, s41, 0
s_cmp_eq_u32 s41, 0
s_cbranch_scc1 Ldefer_81
s_cmp_lt_u32 s28, 6
s_cbranch_scc1 Lyf_82
s_waitcnt vmcnt(0)
s_lshl_b32 s68, s93, 1
s_add_u32 s68, s68, s28
s_add_u32 s68, s68, 314
s_lshl_b32 s68, s68, 7
s_add_u32 s68, s68, 10166272
v_mov_b32 v240, 0
v_mov_b32 v241, s70
s_mov_b64 exec, 1
buffer_store_dword v241, v240, s[64:67], s68 offen sc1
s_mov_b64 exec, -1
Lyf_82:
s_branch concat_heads__linear_attn_block__ssm_conv_h3__prompt_kernel_b3
Ldefer_81:
s_mov_b32 s96, 1
s_sub_u32 s59, s72, 8
s_cmp_lt_u32 s72, 16
s_cselect_b32 s59, s72, s59
concat_heads__linear_attn_block__ssm_conv_h3__prompt_kernel_out:
s_lshl_b32 s29, s71, 2
s_and_b32 s41, s59, 3
s_add_u32 s29, s29, s41
s_lshr_b32 s30, s59, 2
s_barrier
s_add_u32 s41, s28, 0
s_min_u32 s41, s41, 29
s_mul_i32 s42, s41, 6554
s_lshr_b32 s42, s42, 16
s_mul_i32 s43, s42, 10
s_sub_u32 s43, s41, s43
s_lshl_b32 s44, s29, 2
s_add_u32 s44, s44, s43
s_mul_i32 s44, s44, 18432
s_add_u32 s44, s44, 6881280
s_mul_i32 s45, s30, 6
s_add_u32 s45, s45, s43
s_mul_i32 s45, s45, 18432
s_add_u32 s45, s45, 9166848
s_cmp_lt_u32 s43, 4
s_cselect_b32 s44, s44, s45
s_lshl_b32 s42, s42, 10
s_add_u32 s60, s44, s42
s_add_u32 s41, s28, 8
s_min_u32 s41, s41, 29
s_mul_i32 s42, s41, 6554
s_lshr_b32 s42, s42, 16
s_mul_i32 s43, s42, 10
s_sub_u32 s43, s41, s43
s_lshl_b32 s44, s29, 2
s_add_u32 s44, s44, s43
s_mul_i32 s44, s44, 18432
s_add_u32 s44, s44, 6881280
s_mul_i32 s45, s30, 6
s_add_u32 s45, s45, s43
s_mul_i32 s45, s45, 18432
s_add_u32 s45, s45, 9166848
s_cmp_lt_u32 s43, 4
s_cselect_b32 s44, s44, s45
s_lshl_b32 s42, s42, 10
s_add_u32 s61, s44, s42
s_add_u32 s41, s28, 16
s_min_u32 s41, s41, 29
s_mul_i32 s42, s41, 6554
s_lshr_b32 s42, s42, 16
s_mul_i32 s43, s42, 10
s_sub_u32 s43, s41, s43
s_lshl_b32 s44, s29, 2
s_add_u32 s44, s44, s43
s_mul_i32 s44, s44, 18432
s_add_u32 s44, s44, 6881280
s_mul_i32 s45, s30, 6
s_add_u32 s45, s45, s43
s_mul_i32 s45, s45, 18432
s_add_u32 s45, s45, 9166848
s_cmp_lt_u32 s43, 4
s_cselect_b32 s44, s44, s45
s_lshl_b32 s42, s42, 10
s_add_u32 s62, s44, s42
s_add_u32 s41, s28, 24
s_min_u32 s41, s41, 29
s_mul_i32 s42, s41, 6554
s_lshr_b32 s42, s42, 16
s_mul_i32 s43, s42, 10
s_sub_u32 s43, s41, s43
s_lshl_b32 s44, s29, 2
s_add_u32 s44, s44, s43
s_mul_i32 s44, s44, 18432
s_add_u32 s44, s44, 6881280
s_mul_i32 s45, s30, 6
s_add_u32 s45, s45, s43
s_mul_i32 s45, s45, 18432
s_add_u32 s45, s45, 9166848
s_cmp_lt_u32 s43, 4
s_cselect_b32 s44, s44, s45
s_lshl_b32 s42, s42, 10
s_add_u32 s63, s44, s42
v_lshlrev_b32 v2, 4, v0
s_lshl_b32 s44, s28, 10
s_cmp_ge_u32 s28, 6
s_cselect_b32 s45, 1, 0
s_and_b32 s41, s28, 3
s_lshl_b32 s41, s41, 10
v_add_u32 v10, s41, v2
s_lshr_b32 s41, s28, 2
s_mul_i32 s41, s41, 3072
s_add_u32 s41, s41, 4096
v_add_u32 v11, s41, v2
s_mov_b32 s52, s22
s_mov_b32 s53, s23
s_mov_b32 s54, 0x480000
s_mov_b32 s55, 0x20000
v_and_b32 v3, 15, v0
v_lshrrev_b32 v4, 4, v0
s_and_b32 s41, s28, 3
s_lshl_b32 s41, s41, 4
v_add_u32 v3, s41, v3
v_mul_u32_u24 v3, 208, v3
v_lshl_add_u32 v3, v4, 3, v3
s_lshr_b32 s41, s28, 2
s_mul_i32 s41, s41, 96
v_add_u32 v14, s41, v3
s_lshl_b32 s41, s28, 6
s_add_u32 s41, s41, 0
v_add_u32 v5, s41, v0
v_mul_u32_u24 v6, 5462, v5
v_lshrrev_b32 v6, 16, v6
v_mul_u32_u24 v7, 12, v6
v_sub_u32 v7, v5, v7
v_mul_u32_u24 v8, 208, v6
v_lshl_add_u32 v16, v7, 4, v8
s_lshl_b32 s41, s29, 6
v_add_u32 v6, s41, v6
v_mul_u32_u24 v6, 2304, v6
v_lshl_add_u32 v17, v7, 4, v6
s_lshl_b32 s41, s28, 6
s_add_u32 s41, s41, 512
v_add_u32 v5, s41, v0
v_mul_u32_u24 v6, 5462, v5
v_lshrrev_b32 v6, 16, v6
v_mul_u32_u24 v7, 12, v6
v_sub_u32 v7, v5, v7
v_mul_u32_u24 v8, 208, v6
v_lshl_add_u32 v18, v7, 4, v8
s_lshl_b32 s41, s29, 6
v_add_u32 v6, s41, v6
v_mul_u32_u24 v6, 2304, v6
v_lshl_add_u32 v19, v7, 4, v6
s_mul_i32 s46, s30, 192
s_and_b32 s47, s29, 3
s_add_u32 s47, s47, s30
s_cmp_ge_u32 s47, 6
s_cselect_b32 s48, 6, 0
s_sub_u32 s47, s47, s48
s_mov_b32 s47, 0
s_mul_i32 s47, s47, 3072
s_cmp_eq_u32 s96, 0
s_cbranch_scc1 Lnopend_83
s_cmp_lt_u32 s28, 6
s_cbranch_scc1 Lnopend_83
s_waitcnt vmcnt(0)
s_lshl_b32 s68, s93, 1
s_add_u32 s68, s68, s28
s_add_u32 s68, s68, 314
s_lshl_b32 s68, s68, 7
s_add_u32 s68, s68, 10166272
v_mov_b32 v240, 0
v_mov_b32 v241, s70
s_mov_b64 exec, 1
buffer_store_dword v241, v240, s[64:67], s68 offen sc1
s_mov_b64 exec, -1
Lnopend_83:
s_cmp_eq_u32 s28, 5
s_cbranch_scc0 Lwf_84
s_lshr_b32 s68, s29, 1
s_lshl_b32 s68, s68, 2
s_add_u32 s68, s68, 192
v_add_u32 v242, s68, v0
v_add_u32 v241, 252, v0
v_cmp_le_u32 vcc, 4, v0
s_nop 1
v_cndmask_b32 v242, v242, v241, vcc
v_mov_b32 v241, s68
v_cmp_le_u32 vcc, 40, v0
s_nop 1
v_cndmask_b32 v242, v242, v241, vcc
v_lshlrev_b32 v242, 7, v242
v_add_u32 v242, 10166272, v242
s_mov_b32 s69, 0
Lwp_85:
buffer_load_dword v243, v242, s[64:67], 0 offen sc1
s_add_u32 s69, s69, 1
s_waitcnt vmcnt(0)
v_cmp_ne_u32 vcc, s70, v243
s_cmp_ge_u32 s69, 100000
s_cbranch_scc1 Lwf_84
s_cmp_lg_u64 vcc, 0
s_cbranch_scc1 Lwp_85
Lwf_84:
s_barrier
s_add_u32 m0, s44, 0
s_add_u32 s41, s60, s47
buffer_load_dwordx4 v2, s[64:67], s41 offen sc1 lds
s_add_u32 m0, s44, 8192
s_add_u32 s41, s61, s47
buffer_load_dwordx4 v2, s[64:67], s41 offen sc1 lds
s_add_u32 m0, s44, 16384
s_add_u32 s41, s62, s47
buffer_load_dwordx4 v2, s[64:67], s41 offen sc1 lds
s_add_u32 m0, s44, 24576
s_cmp_eq_u32 s45, 0
s_cselect_b32 m0, m0, 153600
s_add_u32 s41, s63, s47
buffer_load_dwordx4 v2, s[64:67], s41 offen sc1 lds
s_add_u32 s47, s47, 3072
s_cmp_eq_u32 s47, 18432
s_cselect_b32 s47, 0, s47
s_barrier
s_add_u32 m0, s44, 30720
s_add_u32 s41, s60, s47
buffer_load_dwordx4 v2, s[64:67], s41 offen sc1 lds
s_add_u32 m0, s44, 38912
s_add_u32 s41, s61, s47
buffer_load_dwordx4 v2, s[64:67], s41 offen sc1 lds
s_add_u32 m0, s44, 47104
s_add_u32 s41, s62, s47
buffer_load_dwordx4 v2, s[64:67], s41 offen sc1 lds
s_add_u32 m0, s44, 55296
s_cmp_eq_u32 s45, 0
s_cselect_b32 m0, m0, 153600
s_add_u32 s41, s63, s47
buffer_load_dwordx4 v2, s[64:67], s41 offen sc1 lds
s_add_u32 s47, s47, 3072
s_cmp_eq_u32 s47, 18432
s_cselect_b32 s47, 0, s47
s_barrier
s_add_u32 m0, s44, 61440
s_add_u32 s41, s60, s47
buffer_load_dwordx4 v2, s[64:67], s41 offen sc1 lds
s_add_u32 m0, s44, 69632
s_add_u32 s41, s61, s47
buffer_load_dwordx4 v2, s[64:67], s41 offen sc1 lds
s_add_u32 m0, s44, 77824
s_add_u32 s41, s62, s47
buffer_load_dwordx4 v2, s[64:67], s41 offen sc1 lds
s_add_u32 m0, s44, 86016
s_cmp_eq_u32 s45, 0
s_cselect_b32 m0, m0, 153600
s_add_u32 s41, s63, s47
buffer_load_dwordx4 v2, s[64:67], s41 offen sc1 lds
s_add_u32 s47, s47, 3072
s_cmp_eq_u32 s47, 18432
s_cselect_b32 s47, 0, s47
s_waitcnt vmcnt(8)
s_barrier
v_add_u32 v12, 0, v10
v_add_u32 v13, 0, v11
ds_read_b128 v[80:83], v12 offset:0
ds_read_b128 v[84:87], v13 offset:0
ds_read_b128 v[88:91], v13 offset:1024
ds_read_b128 v[92:95], v13 offset:2048
ds_read_b128 v[96:99], v12 offset:10240
ds_read_b128 v[100:103], v13 offset:10240
ds_read_b128 v[104:107], v13 offset:11264
ds_read_b128 v[108:111], v13 offset:12288
s_add_u32 m0, s44, 92160
s_add_u32 s41, s60, s47
buffer_load_dwordx4 v2, s[64:67], s41 offen sc1 lds
s_add_u32 m0, s44, 100352
s_add_u32 s41, s61, s47
buffer_load_dwordx4 v2, s[64:67], s41 offen sc1 lds
s_add_u32 m0, s44, 108544
s_add_u32 s41, s62, s47
buffer_load_dwordx4 v2, s[64:67], s41 offen sc1 lds
s_add_u32 m0, s44, 116736
s_cmp_eq_u32 s45, 0
s_cselect_b32 m0, m0, 153600
s_add_u32 s41, s63, s47
buffer_load_dwordx4 v2, s[64:67], s41 offen sc1 lds
s_add_u32 s47, s47, 3072
s_cmp_eq_u32 s47, 18432
s_cselect_b32 s47, 0, s47
s_waitcnt lgkmcnt(6)
v_mfma_f32_16x16x32_bf16 v[64:67], v[84:87], v[80:83], 0
s_waitcnt lgkmcnt(5)
v_mfma_f32_16x16x32_bf16 v[68:71], v[88:91], v[80:83], 0
s_waitcnt lgkmcnt(4)
v_mfma_f32_16x16x32_bf16 v[72:75], v[92:95], v[80:83], 0
ds_read_b128 v[80:83], v12 offset:20480
ds_read_b128 v[84:87], v13 offset:20480
ds_read_b128 v[88:91], v13 offset:21504
ds_read_b128 v[92:95], v13 offset:22528
s_waitcnt lgkmcnt(6)
v_mfma_f32_16x16x32_bf16 v[64:67], v[100:103], v[96:99], v[64:67]
s_waitcnt lgkmcnt(5)
v_mfma_f32_16x16x32_bf16 v[68:71], v[104:107], v[96:99], v[68:71]
s_waitcnt lgkmcnt(4)
v_mfma_f32_16x16x32_bf16 v[72:75], v[108:111], v[96:99], v[72:75]
s_waitcnt lgkmcnt(2)
v_mfma_f32_16x16x32_bf16 v[64:67], v[84:87], v[80:83], v[64:67]
s_waitcnt lgkmcnt(1)
v_mfma_f32_16x16x32_bf16 v[68:71], v[88:91], v[80:83], v[68:71]
s_waitcnt lgkmcnt(0)
v_mfma_f32_16x16x32_bf16 v[72:75], v[92:95], v[80:83], v[72:75]
s_waitcnt vmcnt(8)
s_barrier
v_add_u32 v12, 30720, v10
v_add_u32 v13, 30720, v11
ds_read_b128 v[80:83], v12 offset:0
ds_read_b128 v[84:87], v13 offset:0
ds_read_b128 v[88:91], v13 offset:1024
ds_read_b128 v[92:95], v13 offset:2048
ds_read_b128 v[96:99], v12 offset:10240
ds_read_b128 v[100:103], v13 offset:10240
ds_read_b128 v[104:107], v13 offset:11264
ds_read_b128 v[108:111], v13 offset:12288
s_add_u32 m0, s44, 122880
s_add_u32 s41, s60, s47
buffer_load_dwordx4 v2, s[64:67], s41 offen sc1 lds
s_add_u32 m0, s44, 131072
s_add_u32 s41, s61, s47
buffer_load_dwordx4 v2, s[64:67], s41 offen sc1 lds
s_add_u32 m0, s44, 139264
s_add_u32 s41, s62, s47
buffer_load_dwordx4 v2, s[64:67], s41 offen sc1 lds
s_add_u32 m0, s44, 147456
s_cmp_eq_u32 s45, 0
s_cselect_b32 m0, m0, 153600
s_add_u32 s41, s63, s47
buffer_load_dwordx4 v2, s[64:67], s41 offen sc1 lds
s_add_u32 s47, s47, 3072
s_cmp_eq_u32 s47, 18432
s_cselect_b32 s47, 0, s47
s_waitcnt lgkmcnt(6)
v_mfma_f32_16x16x32_bf16 v[64:67], v[84:87], v[80:83], v[64:67]
s_waitcnt lgkmcnt(5)
v_mfma_f32_16x16x32_bf16 v[68:71], v[88:91], v[80:83], v[68:71]
s_waitcnt lgkmcnt(4)
v_mfma_f32_16x16x32_bf16 v[72:75], v[92:95], v[80:83], v[72:75]
ds_read_b128 v[80:83], v12 offset:20480
ds_read_b128 v[84:87], v13 offset:20480
ds_read_b128 v[88:91], v13 offset:21504
ds_read_b128 v[92:95], v13 offset:22528
s_waitcnt lgkmcnt(6)
v_mfma_f32_16x16x32_bf16 v[64:67], v[100:103], v[96:99], v[64:67]
s_waitcnt lgkmcnt(5)
v_mfma_f32_16x16x32_bf16 v[68:71], v[104:107], v[96:99], v[68:71]
s_waitcnt lgkmcnt(4)
v_mfma_f32_16x16x32_bf16 v[72:75], v[108:111], v[96:99], v[72:75]
s_waitcnt lgkmcnt(2)
v_mfma_f32_16x16x32_bf16 v[64:67], v[84:87], v[80:83], v[64:67]
s_waitcnt lgkmcnt(1)
v_mfma_f32_16x16x32_bf16 v[68:71], v[88:91], v[80:83], v[68:71]
s_waitcnt lgkmcnt(0)
v_mfma_f32_16x16x32_bf16 v[72:75], v[92:95], v[80:83], v[72:75]
s_waitcnt vmcnt(8)
s_barrier
v_add_u32 v12, 61440, v10
v_add_u32 v13, 61440, v11
ds_read_b128 v[80:83], v12 offset:0
ds_read_b128 v[84:87], v13 offset:0
ds_read_b128 v[88:91], v13 offset:1024
ds_read_b128 v[92:95], v13 offset:2048
ds_read_b128 v[96:99], v12 offset:10240
ds_read_b128 v[100:103], v13 offset:10240
ds_read_b128 v[104:107], v13 offset:11264
ds_read_b128 v[108:111], v13 offset:12288
s_add_u32 m0, s44, 0
s_add_u32 s41, s60, s47
buffer_load_dwordx4 v2, s[64:67], s41 offen sc1 lds
s_add_u32 m0, s44, 8192
s_add_u32 s41, s61, s47
buffer_load_dwordx4 v2, s[64:67], s41 offen sc1 lds
s_add_u32 m0, s44, 16384
s_add_u32 s41, s62, s47
buffer_load_dwordx4 v2, s[64:67], s41 offen sc1 lds
s_add_u32 m0, s44, 24576
s_cmp_eq_u32 s45, 0
s_cselect_b32 m0, m0, 153600
s_add_u32 s41, s63, s47
buffer_load_dwordx4 v2, s[64:67], s41 offen sc1 lds
s_add_u32 s47, s47, 3072
s_cmp_eq_u32 s47, 18432
s_cselect_b32 s47, 0, s47
s_waitcnt lgkmcnt(6)
v_mfma_f32_16x16x32_bf16 v[64:67], v[84:87], v[80:83], v[64:67]
s_waitcnt lgkmcnt(5)
v_mfma_f32_16x16x32_bf16 v[68:71], v[88:91], v[80:83], v[68:71]
s_waitcnt lgkmcnt(4)
v_mfma_f32_16x16x32_bf16 v[72:75], v[92:95], v[80:83], v[72:75]
ds_read_b128 v[80:83], v12 offset:20480
ds_read_b128 v[84:87], v13 offset:20480
ds_read_b128 v[88:91], v13 offset:21504
ds_read_b128 v[92:95], v13 offset:22528
s_waitcnt lgkmcnt(6)
v_mfma_f32_16x16x32_bf16 v[64:67], v[100:103], v[96:99], v[64:67]
s_waitcnt lgkmcnt(5)
v_mfma_f32_16x16x32_bf16 v[68:71], v[104:107], v[96:99], v[68:71]
s_waitcnt lgkmcnt(4)
v_mfma_f32_16x16x32_bf16 v[72:75], v[108:111], v[96:99], v[72:75]
s_waitcnt lgkmcnt(2)
v_mfma_f32_16x16x32_bf16 v[64:67], v[84:87], v[80:83], v[64:67]
s_waitcnt lgkmcnt(1)
v_mfma_f32_16x16x32_bf16 v[68:71], v[88:91], v[80:83], v[68:71]
s_waitcnt lgkmcnt(0)
v_mfma_f32_16x16x32_bf16 v[72:75], v[92:95], v[80:83], v[72:75]
s_waitcnt vmcnt(8)
s_barrier
v_add_u32 v12, 92160, v10
v_add_u32 v13, 92160, v11
ds_read_b128 v[80:83], v12 offset:0
ds_read_b128 v[84:87], v13 offset:0
ds_read_b128 v[88:91], v13 offset:1024
ds_read_b128 v[92:95], v13 offset:2048
ds_read_b128 v[96:99], v12 offset:10240
ds_read_b128 v[100:103], v13 offset:10240
ds_read_b128 v[104:107], v13 offset:11264
ds_read_b128 v[108:111], v13 offset:12288
s_waitcnt lgkmcnt(6)
v_mfma_f32_16x16x32_bf16 v[64:67], v[84:87], v[80:83], v[64:67]
s_waitcnt lgkmcnt(5)
v_mfma_f32_16x16x32_bf16 v[68:71], v[88:91], v[80:83], v[68:71]
s_waitcnt lgkmcnt(4)
v_mfma_f32_16x16x32_bf16 v[72:75], v[92:95], v[80:83], v[72:75]
ds_read_b128 v[80:83], v12 offset:20480
ds_read_b128 v[84:87], v13 offset:20480
ds_read_b128 v[88:91], v13 offset:21504
ds_read_b128 v[92:95], v13 offset:22528
s_waitcnt lgkmcnt(6)
v_mfma_f32_16x16x32_bf16 v[64:67], v[100:103], v[96:99], v[64:67]
s_waitcnt lgkmcnt(5)
v_mfma_f32_16x16x32_bf16 v[68:71], v[104:107], v[96:99], v[68:71]
s_waitcnt lgkmcnt(4)
v_mfma_f32_16x16x32_bf16 v[72:75], v[108:111], v[96:99], v[72:75]
s_waitcnt lgkmcnt(2)
v_mfma_f32_16x16x32_bf16 v[64:67], v[84:87], v[80:83], v[64:67]
s_waitcnt lgkmcnt(1)
v_mfma_f32_16x16x32_bf16 v[68:71], v[88:91], v[80:83], v[68:71]
s_waitcnt lgkmcnt(0)
v_mfma_f32_16x16x32_bf16 v[72:75], v[92:95], v[80:83], v[72:75]
s_waitcnt vmcnt(4)
s_barrier
v_add_u32 v12, 122880, v10
v_add_u32 v13, 122880, v11
ds_read_b128 v[80:83], v12 offset:0
ds_read_b128 v[84:87], v13 offset:0
ds_read_b128 v[88:91], v13 offset:1024
ds_read_b128 v[92:95], v13 offset:2048
ds_read_b128 v[96:99], v12 offset:10240
ds_read_b128 v[100:103], v13 offset:10240
ds_read_b128 v[104:107], v13 offset:11264
ds_read_b128 v[108:111], v13 offset:12288
s_waitcnt lgkmcnt(6)
v_mfma_f32_16x16x32_bf16 v[64:67], v[84:87], v[80:83], v[64:67]
s_waitcnt lgkmcnt(5)
v_mfma_f32_16x16x32_bf16 v[68:71], v[88:91], v[80:83], v[68:71]
s_waitcnt lgkmcnt(4)
v_mfma_f32_16x16x32_bf16 v[72:75], v[92:95], v[80:83], v[72:75]
ds_read_b128 v[80:83], v12 offset:20480
ds_read_b128 v[84:87], v13 offset:20480
ds_read_b128 v[88:91], v13 offset:21504
ds_read_b128 v[92:95], v13 offset:22528
s_waitcnt lgkmcnt(6)
v_mfma_f32_16x16x32_bf16 v[64:67], v[100:103], v[96:99], v[64:67]
s_waitcnt lgkmcnt(5)
v_mfma_f32_16x16x32_bf16 v[68:71], v[104:107], v[96:99], v[68:71]
s_waitcnt lgkmcnt(4)
v_mfma_f32_16x16x32_bf16 v[72:75], v[108:111], v[96:99], v[72:75]
s_waitcnt lgkmcnt(2)
v_mfma_f32_16x16x32_bf16 v[64:67], v[84:87], v[80:83], v[64:67]
s_waitcnt lgkmcnt(1)
v_mfma_f32_16x16x32_bf16 v[68:71], v[88:91], v[80:83], v[68:71]
s_waitcnt lgkmcnt(0)
v_mfma_f32_16x16x32_bf16 v[72:75], v[92:95], v[80:83], v[72:75]
s_waitcnt vmcnt(0)
s_barrier
v_add_u32 v12, 0, v10
v_add_u32 v13, 0, v11
ds_read_b128 v[80:83], v12 offset:0
ds_read_b128 v[84:87], v13 offset:0
ds_read_b128 v[88:91], v13 offset:1024
ds_read_b128 v[92:95], v13 offset:2048
ds_read_b128 v[96:99], v12 offset:10240
ds_read_b128 v[100:103], v13 offset:10240
ds_read_b128 v[104:107], v13 offset:11264
ds_read_b128 v[108:111], v13 offset:12288
s_waitcnt lgkmcnt(6)
v_mfma_f32_16x16x32_bf16 v[64:67], v[84:87], v[80:83], v[64:67]
s_waitcnt lgkmcnt(5)
v_mfma_f32_16x16x32_bf16 v[68:71], v[88:91], v[80:83], v[68:71]
s_waitcnt lgkmcnt(4)
v_mfma_f32_16x16x32_bf16 v[72:75], v[92:95], v[80:83], v[72:75]
ds_read_b128 v[80:83], v12 offset:20480
ds_read_b128 v[84:87], v13 offset:20480
ds_read_b128 v[88:91], v13 offset:21504
ds_read_b128 v[92:95], v13 offset:22528
s_waitcnt lgkmcnt(6)
v_mfma_f32_16x16x32_bf16 v[64:67], v[100:103], v[96:99], v[64:67]
s_waitcnt lgkmcnt(5)
v_mfma_f32_16x16x32_bf16 v[68:71], v[104:107], v[96:99], v[68:71]
s_waitcnt lgkmcnt(4)
v_mfma_f32_16x16x32_bf16 v[72:75], v[108:111], v[96:99], v[72:75]
s_waitcnt lgkmcnt(2)
v_mfma_f32_16x16x32_bf16 v[64:67], v[84:87], v[80:83], v[64:67]
s_waitcnt lgkmcnt(1)
v_mfma_f32_16x16x32_bf16 v[68:71], v[88:91], v[80:83], v[68:71]
s_waitcnt lgkmcnt(0)
v_mfma_f32_16x16x32_bf16 v[72:75], v[92:95], v[80:83], v[72:75]
s_nop 3
v_cvt_pk_bf16_f32 v80, v64, v65
v_cvt_pk_bf16_f32 v81, v66, v67
v_cvt_pk_bf16_f32 v82, v68, v69
v_cvt_pk_bf16_f32 v83, v70, v71
v_cvt_pk_bf16_f32 v84, v72, v73
v_cvt_pk_bf16_f32 v85, v74, v75
ds_write_b64 v14, v[80:81] offset:61440
ds_write_b64 v14, v[82:83] offset:61472
ds_write_b64 v14, v[84:85] offset:61504
s_waitcnt lgkmcnt(0)
s_barrier
ds_read_b128 v[88:91], v16 offset:61440
ds_read_b128 v[92:95], v18 offset:61440
s_cmp_ge_u32 s28, 4
s_cbranch_scc1 Lout_86
s_waitcnt lgkmcnt(0)
buffer_store_dwordx4 v[92:95], v19, s[52:55], s46 offen sc1
Lout_86:
s_waitcnt lgkmcnt(0)
buffer_store_dwordx4 v[88:91], v17, s[52:55], s46 offen sc1
s_branch concat_heads__linear_attn_block__ssm_conv_h3__prompt_kernel_fin
concat_heads__linear_attn_block__ssm_conv_h3__prompt_kernel_b3:
s_sub_u32 s58, s73, 64
s_mul_i32 s30, s58, 9363
s_lshr_b32 s30, s30, 16
s_mul_i32 s41, s30, 7
s_sub_u32 s41, s58, s41
s_mul_i32 s42, s28, 7
s_add_u32 s29, s41, s42
s_cmp_ge_u32 s30, 9
s_cbranch_scc1 concat_heads__linear_attn_block__ssm_conv_h3__prompt_kernel_fin
s_barrier
s_cmp_lt_u32 s29, 32
s_cselect_b32 s47, 1, 0
s_cmp_lt_u32 s28, 5
s_cselect_b32 s47, s47, 0
s_cmp_eq_u32 s47, 1
s_cbranch_scc1 Lb3act_87
s_cmp_eq_u32 s28, 5
s_cbranch_scc0 Lwf_89
s_lshl_b32 s68, s30, 5
s_add_u32 s68, s68, 320
v_and_b32 v242, 31, v0
v_add_u32 v242, s68, v242
v_lshlrev_b32 v242, 7, v242
v_add_u32 v242, 10166272, v242
s_mov_b32 s69, 0
Lwp_90:
buffer_load_dword v243, v242, s[64:67], 0 offen sc1
s_add_u32 s69, s69, 1
s_waitcnt vmcnt(0)
v_cmp_ne_u32 vcc, s70, v243
s_cmp_ge_u32 s69, 100000
s_cbranch_scc1 Lwf_89
s_cmp_lg_u64 vcc, 0
s_cbranch_scc1 Lwp_90
Lwf_89:
s_barrier
s_branch concat_heads__linear_attn_block__ssm_conv_h3__prompt_kernel_fin
Lb3act_87:
s_mov_b32 s32, s10
s_mov_b32 s33, s11
s_mov_b32 s34, 0x240000
s_mov_b32 s35, 0x20000
s_mov_b32 s52, s22
s_mov_b32 s53, s23
s_mov_b32 s54, 0x480000
s_mov_b32 s55, 0x20000
s_mul_i32 s44, s28, 17408
v_and_b32 v2, 7, v0
v_lshrrev_b32 v3, 3, v0
s_lshl_b32 s41, s29, 6
v_add_u32 v4, s41, v3
v_mul_u32_u24 v4, 1152, v4
v_lshl_add_u32 v4, v2, 4, v4
s_lshl_b32 s41, s30, 7
v_add_u32 v4, s41, v4
s_mov_b32 s41, 0
buffer_load_dwordx4 v[64:67], v4, s[32:35], s41 offen nt
s_mov_b32 s41, 9216
buffer_load_dwordx4 v[68:71], v4, s[32:35], s41 offen nt
s_mov_b32 s41, 18432
buffer_load_dwordx4 v[72:75], v4, s[32:35], s41 offen nt
s_mov_b32 s41, 27648
buffer_load_dwordx4 v[76:79], v4, s[32:35], s41 offen nt
s_mov_b32 s41, 36864
buffer_load_dwordx4 v[80:83], v4, s[32:35], s41 offen nt
s_mov_b32 s41, 46080
buffer_load_dwordx4 v[84:87], v4, s[32:35], s41 offen nt
s_mov_b32 s41, 55296
buffer_load_dwordx4 v[88:91], v4, s[32:35], s41 offen nt
s_mov_b32 s41, 64512
buffer_load_dwordx4 v[92:95], v4, s[32:35], s41 offen nt
v_lshrrev_b32 v5, 1, v2
v_and_b32 v6, 3, v3
v_xor_b32 v5, v5, v6
v_lshlrev_b32 v5, 1, v5
v_and_b32 v6, 1, v2
v_or_b32 v5, v5, v6
v_lshlrev_b32 v6, 12, v3
v_lshl_add_u32 v6, v5, 4, v6
s_lshl_b32 s41, s30, 18
s_lshl_b32 s42, s29, 7
s_add_u32 s41, s41, s42
s_add_u32 s46, s41, 2359296
v_lshrrev_b32 v7, 4, v0
v_bfe_u32 v8, v0, 2, 2
v_and_b32 v9, 3, v0
v_xor_b32 v10, v7, v8
v_lshlrev_b32 v10, 5, v10
v_lshl_add_u32 v10, v8, 7, v10
v_lshl_add_u32 v10, v9, 3, v10
v_add_u32 v10, s44, v10
v_mul_u32_u24 v11, 144, v0
s_add_u32 s41, s44, 8192
v_add_u32 v11, s41, v11
v_mul_u32_u24 v12, 144, v3
v_lshl_add_u32 v12, v2, 4, v12
v_add_u32 v12, s41, v12
s_lshl_b32 s41, s29, 6
v_add_u32 v13, s41, v3
v_mul_u32_u24 v13, 2304, v13
v_lshl_add_u32 v13, v2, 4, v13
s_lshl_b32 s41, s30, 7
s_add_u32 s41, s41, 1152
v_add_u32 v13, s41, v13
s_mov_b32 s45, 0xffff0000
s_waitcnt vmcnt(0)
s_barrier
s_add_u32 m0, s44, 0
s_add_u32 s42, s46, 0
buffer_load_dwordx4 v6, s[64:67], s42 offen sc1 lds
s_add_u32 m0, s44, 1024
s_add_u32 s42, s46, 32768
buffer_load_dwordx4 v6, s[64:67], s42 offen sc1 lds
s_add_u32 m0, s44, 2048
s_add_u32 s42, s46, 65536
buffer_load_dwordx4 v6, s[64:67], s42 offen sc1 lds
s_add_u32 m0, s44, 3072
s_add_u32 s42, s46, 98304
buffer_load_dwordx4 v6, s[64:67], s42 offen sc1 lds
s_add_u32 m0, s44, 4096
s_add_u32 s42, s46, 131072
buffer_load_dwordx4 v6, s[64:67], s42 offen sc1 lds
s_add_u32 m0, s44, 5120
s_add_u32 s42, s46, 163840
buffer_load_dwordx4 v6, s[64:67], s42 offen sc1 lds
s_add_u32 m0, s44, 6144
s_add_u32 s42, s46, 196608
buffer_load_dwordx4 v6, s[64:67], s42 offen sc1 lds
s_add_u32 m0, s44, 7168
s_add_u32 s42, s46, 229376
buffer_load_dwordx4 v6, s[64:67], s42 offen sc1 lds
v_lshlrev_b32 v144, 16, v64
v_and_b32 v145, s45, v64
v_lshlrev_b32 v146, 16, v65
v_and_b32 v147, s45, v65
v_lshlrev_b32 v148, 16, v66
v_and_b32 v149, s45, v66
v_lshlrev_b32 v150, 16, v67
v_and_b32 v151, s45, v67
v_lshlrev_b32 v152, 16, v68
v_and_b32 v153, s45, v68
v_lshlrev_b32 v154, 16, v69
v_and_b32 v155, s45, v69
v_lshlrev_b32 v156, 16, v70
v_and_b32 v157, s45, v70
v_lshlrev_b32 v158, 16, v71
v_and_b32 v159, s45, v71
v_lshlrev_b32 v160, 16, v72
v_and_b32 v161, s45, v72
v_lshlrev_b32 v162, 16, v73
v_and_b32 v163, s45, v73
v_lshlrev_b32 v164, 16, v74
v_and_b32 v165, s45, v74
v_lshlrev_b32 v166, 16, v75
v_and_b32 v167, s45, v75
v_lshlrev_b32 v168, 16, v76
v_and_b32 v169, s45, v76
v_lshlrev_b32 v170, 16, v77
v_and_b32 v171, s45, v77
v_lshlrev_b32 v172, 16, v78
v_and_b32 v173, s45, v78
v_lshlrev_b32 v174, 16, v79
v_and_b32 v175, s45, v79
v_lshlrev_b32 v176, 16, v80
v_and_b32 v177, s45, v80
v_lshlrev_b32 v178, 16, v81
v_and_b32 v179, s45, v81
v_lshlrev_b32 v180, 16, v82
v_and_b32 v181, s45, v82
v_lshlrev_b32 v182, 16, v83
v_and_b32 v183, s45, v83
v_lshlrev_b32 v184, 16, v84
v_and_b32 v185, s45, v84
v_lshlrev_b32 v186, 16, v85
v_and_b32 v187, s45, v85
v_lshlrev_b32 v188, 16, v86
v_and_b32 v189, s45, v86
v_lshlrev_b32 v190, 16, v87
v_and_b32 v191, s45, v87
v_lshlrev_b32 v192, 16, v88
v_and_b32 v193, s45, v88
v_lshlrev_b32 v194, 16, v89
v_and_b32 v195, s45, v89
v_lshlrev_b32 v196, 16, v90
v_and_b32 v197, s45, v90
v_lshlrev_b32 v198, 16, v91
v_and_b32 v199, s45, v91
v_lshlrev_b32 v200, 16, v92
v_and_b32 v201, s45, v92
v_lshlrev_b32 v202, 16, v93
v_and_b32 v203, s45, v93
v_lshlrev_b32 v204, 16, v94
v_and_b32 v205, s45, v94
v_lshlrev_b32 v206, 16, v95
v_and_b32 v207, s45, v95
s_waitcnt vmcnt(0)
ds_read_b64_tr_b16 v[96:97], v10 offset:0
ds_read_b64_tr_b16 v[98:99], v10 offset:512
ds_read_b64_tr_b16 v[100:101], v10 offset:1024
ds_read_b64_tr_b16 v[102:103], v10 offset:1536
ds_read_b64_tr_b16 v[104:105], v10 offset:2048
ds_read_b64_tr_b16 v[106:107], v10 offset:2560
ds_read_b64_tr_b16 v[108:109], v10 offset:3072
ds_read_b64_tr_b16 v[110:111], v10 offset:3584
ds_read_b64_tr_b16 v[112:113], v10 offset:4096
ds_read_b64_tr_b16 v[114:115], v10 offset:4608
ds_read_b64_tr_b16 v[116:117], v10 offset:5120
ds_read_b64_tr_b16 v[118:119], v10 offset:5632
ds_read_b64_tr_b16 v[120:121], v10 offset:6144
ds_read_b64_tr_b16 v[122:123], v10 offset:6656
ds_read_b64_tr_b16 v[124:125], v10 offset:7168
ds_read_b64_tr_b16 v[126:127], v10 offset:7680
s_waitcnt lgkmcnt(14)
ds_write_b64 v11, v[96:97] offset:0
s_waitcnt lgkmcnt(14)
ds_write_b64 v11, v[98:99] offset:8
s_waitcnt lgkmcnt(14)
ds_write_b64 v11, v[100:101] offset:16
s_waitcnt lgkmcnt(14)
ds_write_b64 v11, v[102:103] offset:24
s_waitcnt lgkmcnt(14)
ds_write_b64 v11, v[104:105] offset:32
s_waitcnt lgkmcnt(14)
ds_write_b64 v11, v[106:107] offset:40
s_waitcnt lgkmcnt(14)
ds_write_b64 v11, v[108:109] offset:48
s_waitcnt lgkmcnt(14)
ds_write_b64 v11, v[110:111] offset:56
s_waitcnt lgkmcnt(14)
ds_write_b64 v11, v[112:113] offset:64
s_waitcnt lgkmcnt(14)
ds_write_b64 v11, v[114:115] offset:72
s_waitcnt lgkmcnt(14)
ds_write_b64 v11, v[116:117] offset:80
s_waitcnt lgkmcnt(14)
ds_write_b64 v11, v[118:119] offset:88
s_waitcnt lgkmcnt(14)
ds_write_b64 v11, v[120:121] offset:96
s_waitcnt lgkmcnt(14)
ds_write_b64 v11, v[122:123] offset:104
s_waitcnt lgkmcnt(14)
ds_write_b64 v11, v[124:125] offset:112
s_waitcnt lgkmcnt(14)
ds_write_b64 v11, v[126:127] offset:120
s_waitcnt lgkmcnt(0)
ds_read_b128 v[96:99], v12 offset:0
ds_read_b128 v[100:103], v12 offset:1152
ds_read_b128 v[104:107], v12 offset:2304
ds_read_b128 v[108:111], v12 offset:3456
ds_read_b128 v[112:115], v12 offset:4608
ds_read_b128 v[116:119], v12 offset:5760
ds_read_b128 v[120:123], v12 offset:6912
ds_read_b128 v[124:127], v12 offset:8064
s_waitcnt lgkmcnt(7)
v_lshlrev_b32 v128, 16, v96
v_and_b32 v129, s45, v96
v_lshlrev_b32 v130, 16, v97
v_and_b32 v131, s45, v97
v_lshlrev_b32 v132, 16, v98
v_and_b32 v133, s45, v98
v_lshlrev_b32 v134, 16, v99
v_and_b32 v135, s45, v99
v_mul_f32 v128, v128, v144
v_mul_f32 v129, v129, v145
v_mul_f32 v130, v130, v146
v_mul_f32 v131, v131, v147
v_mul_f32 v132, v132, v148
v_mul_f32 v133, v133, v149
v_mul_f32 v134, v134, v150
v_mul_f32 v135, v135, v151
v_cvt_pk_bf16_f32 v64, v128, v129
v_cvt_pk_bf16_f32 v65, v130, v131
v_cvt_pk_bf16_f32 v66, v132, v133
v_cvt_pk_bf16_f32 v67, v134, v135
s_mov_b32 s41, 0
buffer_store_dwordx4 v[64:67], v13, s[52:55], s41 offen sc1
s_waitcnt lgkmcnt(6)
v_lshlrev_b32 v128, 16, v100
v_and_b32 v129, s45, v100
v_lshlrev_b32 v130, 16, v101
v_and_b32 v131, s45, v101
v_lshlrev_b32 v132, 16, v102
v_and_b32 v133, s45, v102
v_lshlrev_b32 v134, 16, v103
v_and_b32 v135, s45, v103
v_mul_f32 v128, v128, v152
v_mul_f32 v129, v129, v153
v_mul_f32 v130, v130, v154
v_mul_f32 v131, v131, v155
v_mul_f32 v132, v132, v156
v_mul_f32 v133, v133, v157
v_mul_f32 v134, v134, v158
v_mul_f32 v135, v135, v159
v_cvt_pk_bf16_f32 v68, v128, v129
v_cvt_pk_bf16_f32 v69, v130, v131
v_cvt_pk_bf16_f32 v70, v132, v133
v_cvt_pk_bf16_f32 v71, v134, v135
s_mov_b32 s41, 18432
buffer_store_dwordx4 v[68:71], v13, s[52:55], s41 offen sc1
s_waitcnt lgkmcnt(5)
v_lshlrev_b32 v128, 16, v104
v_and_b32 v129, s45, v104
v_lshlrev_b32 v130, 16, v105
v_and_b32 v131, s45, v105
v_lshlrev_b32 v132, 16, v106
v_and_b32 v133, s45, v106
v_lshlrev_b32 v134, 16, v107
v_and_b32 v135, s45, v107
v_mul_f32 v128, v128, v160
v_mul_f32 v129, v129, v161
v_mul_f32 v130, v130, v162
v_mul_f32 v131, v131, v163
v_mul_f32 v132, v132, v164
v_mul_f32 v133, v133, v165
v_mul_f32 v134, v134, v166
v_mul_f32 v135, v135, v167
v_cvt_pk_bf16_f32 v72, v128, v129
v_cvt_pk_bf16_f32 v73, v130, v131
v_cvt_pk_bf16_f32 v74, v132, v133
v_cvt_pk_bf16_f32 v75, v134, v135
s_mov_b32 s41, 36864
buffer_store_dwordx4 v[72:75], v13, s[52:55], s41 offen sc1
s_waitcnt lgkmcnt(4)
v_lshlrev_b32 v128, 16, v108
v_and_b32 v129, s45, v108
v_lshlrev_b32 v130, 16, v109
v_and_b32 v131, s45, v109
v_lshlrev_b32 v132, 16, v110
v_and_b32 v133, s45, v110
v_lshlrev_b32 v134, 16, v111
v_and_b32 v135, s45, v111
v_mul_f32 v128, v128, v168
v_mul_f32 v129, v129, v169
v_mul_f32 v130, v130, v170
v_mul_f32 v131, v131, v171
v_mul_f32 v132, v132, v172
v_mul_f32 v133, v133, v173
v_mul_f32 v134, v134, v174
v_mul_f32 v135, v135, v175
v_cvt_pk_bf16_f32 v76, v128, v129
v_cvt_pk_bf16_f32 v77, v130, v131
v_cvt_pk_bf16_f32 v78, v132, v133
v_cvt_pk_bf16_f32 v79, v134, v135
s_mov_b32 s41, 55296
buffer_store_dwordx4 v[76:79], v13, s[52:55], s41 offen sc1
s_waitcnt lgkmcnt(3)
v_lshlrev_b32 v128, 16, v112
v_and_b32 v129, s45, v112
v_lshlrev_b32 v130, 16, v113
v_and_b32 v131, s45, v113
v_lshlrev_b32 v132, 16, v114
v_and_b32 v133, s45, v114
v_lshlrev_b32 v134, 16, v115
v_and_b32 v135, s45, v115
v_mul_f32 v128, v128, v176
v_mul_f32 v129, v129, v177
v_mul_f32 v130, v130, v178
v_mul_f32 v131, v131, v179
v_mul_f32 v132, v132, v180
v_mul_f32 v133, v133, v181
v_mul_f32 v134, v134, v182
v_mul_f32 v135, v135, v183
v_cvt_pk_bf16_f32 v80, v128, v129
v_cvt_pk_bf16_f32 v81, v130, v131
v_cvt_pk_bf16_f32 v82, v132, v133
v_cvt_pk_bf16_f32 v83, v134, v135
s_mov_b32 s41, 73728
buffer_store_dwordx4 v[80:83], v13, s[52:55], s41 offen sc1
s_waitcnt lgkmcnt(2)
v_lshlrev_b32 v128, 16, v116
v_and_b32 v129, s45, v116
v_lshlrev_b32 v130, 16, v117
v_and_b32 v131, s45, v117
v_lshlrev_b32 v132, 16, v118
v_and_b32 v133, s45, v118
v_lshlrev_b32 v134, 16, v119
v_and_b32 v135, s45, v119
v_mul_f32 v128, v128, v184
v_mul_f32 v129, v129, v185
v_mul_f32 v130, v130, v186
v_mul_f32 v131, v131, v187
v_mul_f32 v132, v132, v188
v_mul_f32 v133, v133, v189
v_mul_f32 v134, v134, v190
v_mul_f32 v135, v135, v191
v_cvt_pk_bf16_f32 v84, v128, v129
v_cvt_pk_bf16_f32 v85, v130, v131
v_cvt_pk_bf16_f32 v86, v132, v133
v_cvt_pk_bf16_f32 v87, v134, v135
s_mov_b32 s41, 92160
buffer_store_dwordx4 v[84:87], v13, s[52:55], s41 offen sc1
s_waitcnt lgkmcnt(1)
v_lshlrev_b32 v128, 16, v120
v_and_b32 v129, s45, v120
v_lshlrev_b32 v130, 16, v121
v_and_b32 v131, s45, v121
v_lshlrev_b32 v132, 16, v122
v_and_b32 v133, s45, v122
v_lshlrev_b32 v134, 16, v123
v_and_b32 v135, s45, v123
v_mul_f32 v128, v128, v192
v_mul_f32 v129, v129, v193
v_mul_f32 v130, v130, v194
v_mul_f32 v131, v131, v195
v_mul_f32 v132, v132, v196
v_mul_f32 v133, v133, v197
v_mul_f32 v134, v134, v198
v_mul_f32 v135, v135, v199
v_cvt_pk_bf16_f32 v88, v128, v129
v_cvt_pk_bf16_f32 v89, v130, v131
v_cvt_pk_bf16_f32 v90, v132, v133
v_cvt_pk_bf16_f32 v91, v134, v135
s_mov_b32 s41, 110592
buffer_store_dwordx4 v[88:91], v13, s[52:55], s41 offen sc1
s_waitcnt lgkmcnt(0)
v_lshlrev_b32 v128, 16, v124
v_and_b32 v129, s45, v124
v_lshlrev_b32 v130, 16, v125
v_and_b32 v131, s45, v125
v_lshlrev_b32 v132, 16, v126
v_and_b32 v133, s45, v126
v_lshlrev_b32 v134, 16, v127
v_and_b32 v135, s45, v127
v_mul_f32 v128, v128, v200
v_mul_f32 v129, v129, v201
v_mul_f32 v130, v130, v202
v_mul_f32 v131, v131, v203
v_mul_f32 v132, v132, v204
v_mul_f32 v133, v133, v205
v_mul_f32 v134, v134, v206
v_mul_f32 v135, v135, v207
v_cvt_pk_bf16_f32 v92, v128, v129
v_cvt_pk_bf16_f32 v93, v130, v131
v_cvt_pk_bf16_f32 v94, v132, v133
v_cvt_pk_bf16_f32 v95, v134, v135
s_mov_b32 s41, 129024
buffer_store_dwordx4 v[92:95], v13, s[52:55], s41 offen sc1
concat_heads__linear_attn_block__ssm_conv_h3__prompt_kernel_fin:
concat_heads__linear_attn_block__ssm_conv_h3__prompt_kernel_end:
s_endpgm
Lcode_end:
.section .rodata,"a"
.p2align 6
.amdhsa_kernel concat_heads__linear_attn_block__ssm_conv_h3__prompt_kernel
  .amdhsa_next_free_vgpr 256
  .amdhsa_next_free_sgpr 102
  .amdhsa_accum_offset 256
  .amdhsa_group_segment_fixed_size 0
  .amdhsa_kernarg_size 96
  .amdhsa_user_sgpr_count 2
  .amdhsa_user_sgpr_kernarg_segment_ptr 1
  .amdhsa_system_sgpr_workgroup_id_x 1
  .amdhsa_float_denorm_mode_32 3
.end_amdhsa_kernel
.text
```
